```python
import torch

def _softmax(x, axis=-1):
    return torch.softmax(x, dim=axis)
def _gelu(x):
    return torch.nn.functional.gelu(x, approximate="tanh")
def _silu(x):
    return torch.nn.functional.silu(x)
def _sigmoid(x):
    return torch.sigmoid(x)
def _layernorm(x, axis=-1, eps=1e-5):
    m = x.mean(dim=axis, keepdim=True)
    v = x.var(dim=axis, keepdim=True, unbiased=False)
    return (x - m) / torch.sqrt(v + eps)
def _scatter_add(tgt, idx, src, axis=0):
    return tgt.clone().index_add_(axis, idx, src)
def _segment_sum(src, seg, n):
    out = torch.zeros((n,) + src.shape[1:], dtype=src.dtype)
    return out.index_add_(0, seg, src)
def _pad(x, pw):
    flat = tuple(v for pair in reversed(pw) for v in pair)
    return torch.nn.functional.pad(x, flat)

kernel_name = 'gated_mix__ssm_conv_s4__dense_activation_relu__prompt'

def setup_inputs():

    _w = (lambda a: (lambda t: t.to(torch.bfloat16) if t.is_floating_point() else t)(torch.as_tensor(a)))
    def _A_setup():
        B, L, D, N = 1, 2048, 512, 128
        A_re = -(lambda _x: torch.exp(torch.as_tensor(_x)))((lambda *s: torch.randn(*s, dtype=torch.bfloat16) * 3.2)(D, N))
        A_im = torch.pi * (lambda *s: torch.randn(*s, dtype=torch.bfloat16) * 0.1)(D, N)
        B_re = (lambda *s: torch.randn(*s, dtype=torch.bfloat16) * 0.4)(D, N)
        B_im = (lambda *s: torch.randn(*s, dtype=torch.bfloat16) * 0.4)(D, N)
        C_re = (lambda *s: torch.randn(*s, dtype=torch.bfloat16) * 0.4)(D, N)
        C_im = (lambda *s: torch.randn(*s, dtype=torch.bfloat16) * 0.4)(D, N)
        log_dt = (lambda *s: torch.randn(*s, dtype=torch.bfloat16) * 0.1)(D) * 0.5 - 4.0
        Dskip = (lambda *s: torch.randn(*s, dtype=torch.bfloat16) * 0.2)(D)
        return {
            "u": _w((lambda *s: torch.randn(*s, dtype=torch.bfloat16) * 0.05)(B, L, D)),
            "A_re": _w(A_re),
            "A_im": _w(A_im),
            "B_re": _w(B_re),
            "B_im": _w(B_im),
            "C_re": _w(C_re),
            "C_im": _w(C_im),
            "log_dt": _w(log_dt),
            "Dskip": _w(Dskip),
        }
    _A_in = _A_setup()

    def _B_setup():
        B, S, D, Dff = 1, 2048, 512, 1376
        return {
            "x": _w((lambda *s: torch.randn(*s, dtype=torch.bfloat16) * 0.05)(B, S, D)),
            "w1": _w((lambda *s: torch.randn(*s, dtype=torch.bfloat16) * 0.05)(D, Dff)),
            "w2": _w((lambda *s: torch.randn(*s, dtype=torch.bfloat16) * 0.05)(Dff, D)),
        }
    _B_in = _B_setup()

    return {
        "A_u": _A_in["u"],
        "A_A_re": _A_in["A_re"],
        "A_A_im": _A_in["A_im"],
        "A_B_re": _A_in["B_re"],
        "A_B_im": _A_in["B_im"],
        "A_C_re": _A_in["C_re"],
        "A_C_im": _A_in["C_im"],
        "A_log_dt": _A_in["log_dt"],
        "A_Dskip": _A_in["Dskip"],
        "B_x": _B_in["x"],
        "B_w1": _B_in["w1"],
        "B_w2": _B_in["w2"],
        "gate_w": _w((lambda *s: torch.randn(*s, dtype=torch.bfloat16) * 0.05)(512) * 16.0),
    }

def reference(A_u, A_A_re, A_A_im, A_B_re, A_B_im, A_C_re, A_C_im, A_log_dt, A_Dskip, B_x, B_w1, B_w2, gate_w):
    def _A_ref(u, A_re, A_im, B_re, B_im, C_re, C_im, log_dt, Dskip):
        Bsz, L, D = u.shape
        dt = torch.exp(log_dt)[:, None]
        A = A_re + 1j * A_im
        Bc = B_re + 1j * B_im
        Cc = C_re + 1j * C_im
        logdA = dt * A
        dB = dt * Bc
        l = (lambda x, dt: x.to(dt))(torch.arange(L), A_re.dtype)
        P = torch.exp(logdA[:, :, None] * l[None, None, :])
        K = torch.einsum("dn,dnl,dn->dl", Cc, P, dB).real
        L2 = 2 * L
        Kp = _pad(K, ((0, 0), (0, L)))
        up = (lambda x, *d: x.permute(*d))(u, 0, 2, 1)
        up = _pad(up, ((0, 0), (0, 0), (0, L)))
        Kf = (lambda x, axes=(-2,-1): torch.fft.rfft2(x.float(), dim=axes))(Kp[:, None, :], axes=(-2, -1))
        Uf = (lambda x, axes=(-2,-1): torch.fft.rfft2(x.float(), dim=axes))(up[:, :, None, :], axes=(-2, -1))
        Yf = Uf * Kf[None, :, :, :]
        y = (lambda x, s, axes=(-2,-1): torch.fft.irfft2(x, s=s, dim=axes).to(torch.bfloat16))(Yf, (1, L2), axes=(-2, -1))[:, :, 0, :L]
        y = (lambda x, *d: x.permute(*d))(y, 0, 2, 1) + u * Dskip[None, None, :]
        return y

    def _B_ref(x, w1, w2):
        h = torch.einsum("bsd,df->bsf", x, w1)
        zero = torch.zeros_like(h)
        h = torch.maximum(h, zero)
        return torch.einsum("bsf,fd->bsd", h, w2)

    x = A_u
    g = _sigmoid((x * gate_w).sum(-1, keepdims=True))
    a = _A_ref(x, A_A_re, A_A_im, A_B_re, A_B_im, A_C_re, A_C_im, A_log_dt, A_Dskip)
    b = _B_ref(x, B_w1, B_w2)
    return g * a + (1 - g) * b
```

```asm
; @launch grid=(256,1,1) block=(256,1,1) lds=163840
.amdgcn_target "amdgcn-amd-amdhsa--gfx950"
.text
.globl gated_mix__ssm_conv_s4__dense_activation_relu__prompt_kernel
.p2align 8
.type gated_mix__ssm_conv_s4__dense_activation_relu__prompt_kernel,@function
gated_mix__ssm_conv_s4__dense_activation_relu__prompt_kernel:
    s_cmp_ge_u32 s2, 256
    s_cbranch_scc1 END
    s_load_dwordx16 s[4:19], s[0:1], 0
    s_load_dwordx16 s[20:35], s[0:1], 64
    v_and_b32 v1, 63, v0
    v_lshrrev_b32 v32, 6, v0
    s_and_b32 s65, s2, 7
    v_readfirstlane_b32 s64, v32
    s_lshr_b32 s66, s2, 3
    s_lshr_b32 s74, s65, 1
    s_and_b32 s75, s65, 1
    s_and_b32 s76, s66, 3
    s_lshl_b32 s67, s74, 2
    s_add_u32 s67, s67, s76
    s_lshr_b32 s73, s66, 2
    s_lshl_b32 s68, s75, 3
    s_add_u32 s68, s68, s73
    s_lshl_b32 s69, s74, 3
    s_and_b32 s77, s66, 7
    s_add_u32 s69, s69, s77
    s_lshl_b32 s70, s75, 2
    s_lshr_b32 s77, s66, 3
    s_add_u32 s70, s70, s77
    s_lshl_b32 s71, s65, 6
    s_lshl_b32 s77, s66, 1
    s_add_u32 s71, s71, s77
    s_lshr_b32 s72, s65, 1
    s_lshl_b32 s72, s72, 3
    s_and_b32 s77, s66, 7
    s_add_u32 s72, s72, s77
    s_and_b32 s73, s65, 1
    s_lshl_b32 s73, s73, 2
    s_lshr_b32 s77, s66, 3
    s_add_u32 s73, s73, s77
    v_lshrrev_b32 v32, 3, v1
    v_and_b32 v33, 7, v1
    v_lshrrev_b32 v34, 4, v1
    v_lshlrev_b32 v35, 10, v32
    v_lshl_add_u32 v36, v33, 4, v35
    s_lshr_b32 s74, s64, 1
    s_add_u32 s74, s74, s71
    s_and_b32 s75, s64, 1
    s_lshl_b32 s76, s74, 8
    s_lshl_b32 s75, s75, 7
    s_add_u32 s76, s76, s75
    v_lshl_add_u32 v56, v1, 1, s76
    s_lshl_b32 s74, s74, 1
    v_mov_b32 v57, s74
    s_lshl_b32 s74, s69, 6
    s_lshl_b32 s75, s64, 4
    s_add_u32 s74, s74, s75
    s_lshl_b32 s74, s74, 10
    s_lshl_b32 s76, s70, 7
    s_add_u32 s100, s74, s76
    s_lshl_b32 s77, s64, 11
    s_add_u32 s3, s77, 32768
    s_add_u32 s101, s100, 7168
    s_lshl_b32 s78, s69, 16
    s_sub_u32 s78, s78, 1024
    s_add_u32 s78, s78, s76
    s_lshl_b32 s79, s64, 5
    s_add_u32 s78, s78, s79
    v_lshl_add_u32 v58, v32, 1, s78
    v_add_u32 v59, 16, v58
    s_waitcnt lgkmcnt(0)
    global_load_ushort v46, v56, s[6:7]
    global_load_ushort v47, v56, s[8:9]
    global_load_ushort v48, v56, s[10:11]
    global_load_ushort v49, v56, s[12:13]
    global_load_ushort v50, v56, s[14:15]
    global_load_ushort v51, v56, s[16:17]
    global_load_ushort v52, v57, s[18:19]
    global_load_ushort v53, v57, s[20:21]
    s_mov_b32 s36, s4
    s_mov_b32 s37, s5
    s_mov_b32 s38, 2097152
    s_mov_b32 s39, 0x20000
    s_mov_b32 m0, s3
    s_nop 0
    buffer_load_dwordx4 v36, s[36:39], s100 offen lds
    buffer_load_dwordx4 v36, s[36:39], s101 offen offset:1024 lds
    buffer_load_short_d16_hi v172, v58, s[36:39], 0 offen
    buffer_load_short_d16_hi v173, v59, s[36:39], 0 offen
    s_mov_b32 s56, s32
    s_mov_b32 s57, s33
    s_mov_b32 s58, 256
    s_mov_b32 s59, 0x20000
    s_cmp_lg_u32 s2, 0
    s_cbranch_scc1 NW_1
    s_cmp_lg_u32 s64, 0
    s_cbranch_scc1 NW_1
    s_memrealtime s[98:99]
    s_waitcnt lgkmcnt(0)
    s_or_b32 s98, s98, 1
    v_mov_b32 v26, s98
    v_mov_b32 v27, s99
    s_mov_b64 exec, 1
    buffer_store_dwordx2 v[26:27], off, s[56:59], 0 sc1
    s_mov_b64 exec, -1
NW_1:
    s_mov_b32 s40, s24
    s_mov_b32 s41, s25
    s_mov_b32 s42, 1409024
    s_mov_b32 s43, 0x20000
    s_lshl_b32 s23, s64, 12
    s_mul_i32 s3, s64, 3072
    s_and_b32 s19, s66, 3
    s_lshl_b32 s19, s19, 1
    s_lshr_b32 s18, s66, 2
    s_add_u32 s19, s19, s18
    v_xor_b32 v37, v33, v34
    v_lshl_add_u32 v2, v37, 4, v35
    v_xor_b32 v37, 4, v37
    v_lshl_add_u32 v3, v37, 4, v35
    v_add_u32 v3, 7168, v3
    v_add_u32 v30, 14336, v2
    v_add_u32 v25, 14336, v3
    v_lshlrev_b32 v14, 4, v1
    s_cmp_ge_u32 s68, 14
    s_cselect_b32 s78, 3, 15
    v_add_u32 v37, 0, v1
    v_mul_u32_u24 v38, 0x5556, v37
    v_lshrrev_b32 v38, 18, v38
    v_mul_u32_u24 v39, 12, v38
    v_sub_u32 v39, v37, v39
    v_lshrrev_b32 v40, 3, v38
    v_lshlrev_b32 v40, 1, v40
    v_xor_b32 v39, v39, v40
    v_and_b32 v39, s78, v39
    v_mul_u32_u24 v38, 0xac0, v38
    v_lshl_add_u32 v4, v39, 4, v38
    v_add_u32 v37, 64, v1
    v_mul_u32_u24 v38, 0x5556, v37
    v_lshrrev_b32 v38, 18, v38
    v_mul_u32_u24 v39, 12, v38
    v_sub_u32 v39, v37, v39
    v_lshrrev_b32 v40, 3, v38
    v_lshlrev_b32 v40, 1, v40
    v_xor_b32 v39, v39, v40
    v_and_b32 v39, s78, v39
    v_mul_u32_u24 v38, 0xac0, v38
    v_lshl_add_u32 v5, v39, 4, v38
    v_subrev_u32 v5, 1024, v5
    v_add_u32 v37, 128, v1
    v_mul_u32_u24 v38, 0x5556, v37
    v_lshrrev_b32 v38, 18, v38
    v_mul_u32_u24 v39, 12, v38
    v_sub_u32 v39, v37, v39
    v_lshrrev_b32 v40, 3, v38
    v_lshlrev_b32 v40, 1, v40
    v_xor_b32 v39, v39, v40
    v_and_b32 v39, s78, v39
    v_mul_u32_u24 v38, 0xac0, v38
    v_lshl_add_u32 v6, v39, 4, v38
    v_subrev_u32 v6, 2048, v6
    s_lshl_b32 s74, s67, 7
    s_lshl_b32 s75, s64, 5
    s_add_u32 s74, s74, s75
    s_lshl_b32 s80, s74, 10
    s_min_u32 s74, s68, 14
    s_mul_i32 s74, s74, 192
    s_mul_i32 s75, s64, 44032
    s_add_u32 s81, s74, s75
    s_add_u32 m0, s23, 0
    s_add_u32 s18, s19, 0
    s_and_b32 s18, s18, 7
    s_lshl_b32 s22, s18, 7
    s_add_u32 s22, s22, s80
    buffer_load_dwordx4 v2, s[36:39], s22 offen lds
    buffer_load_dwordx4 v3, s[36:39], s22 offen offset:1024 lds
    buffer_load_dwordx4 v30, s[36:39], s22 offen offset:2048 lds
    buffer_load_dwordx4 v25, s[36:39], s22 offen offset:3072 lds
    s_add_u32 m0, s3, 49152
    s_mul_i32 s21, s18, 176128
    s_add_u32 s21, s21, s81
    buffer_load_dwordx4 v4, s[40:43], s21 offen lds
    buffer_load_dwordx4 v5, s[40:43], s21 offen offset:1024 lds
    buffer_load_dwordx4 v6, s[40:43], s21 offen offset:2048 lds
    s_add_u32 m0, s23, 16384
    s_add_u32 s18, s19, 1
    s_and_b32 s18, s18, 7
    s_lshl_b32 s22, s18, 7
    s_add_u32 s22, s22, s80
    buffer_load_dwordx4 v2, s[36:39], s22 offen lds
    buffer_load_dwordx4 v3, s[36:39], s22 offen offset:1024 lds
    buffer_load_dwordx4 v30, s[36:39], s22 offen offset:2048 lds
    buffer_load_dwordx4 v25, s[36:39], s22 offen offset:3072 lds
    s_add_u32 m0, s3, 61440
    s_mul_i32 s21, s18, 176128
    s_add_u32 s21, s21, s81
    buffer_load_dwordx4 v4, s[40:43], s21 offen lds
    buffer_load_dwordx4 v5, s[40:43], s21 offen offset:1024 lds
    buffer_load_dwordx4 v6, s[40:43], s21 offen offset:2048 lds
    s_mov_b32 s44, s26
    s_mov_b32 s45, s27
    s_mov_b32 s46, 1409024
    s_mov_b32 s47, 0x20000
    s_mov_b32 s48, s34
    s_mov_b32 s49, s35
    s_mov_b32 s50, 16777216
    s_mov_b32 s51, 0x20000
    s_mov_b32 s52, s30
    s_mov_b32 s53, s31
    s_mov_b32 s54, 2097152
    s_mov_b32 s55, 0x20000
    s_add_u32 s60, s34, 4718592
    s_addc_u32 s61, s35, 0
    s_mov_b32 s62, 5636096
    s_mov_b32 s63, 0x20000
    v_and_b32 v37, 15, v1
    v_lshrrev_b32 v38, 2, v37
    v_and_b32 v39, 3, v1
    v_and_b32 v40, 1, v34
    v_lshrrev_b32 v41, 1, v34
    s_lshl_b32 s74, s64, 12
    v_lshrrev_b32 v42, 1, v37
    v_xor_b32 v42, v42, v34
    v_lshlrev_b32 v43, 7, v37
    v_add_u32 v43, s74, v43
    v_lshl_add_u32 v7, v42, 4, v43
    v_xor_b32 v42, 4, v42
    v_lshl_add_u32 v8, v42, 4, v43
    v_lshl_add_u32 v42, v34, 3, v38
    v_mul_u32_u24 v42, 192, v42
    v_lshl_add_u32 v42, v39, 3, v42
    v_add_u32 v42, 49152, v42
    v_lshlrev_b32 v43, 5, v40
    v_add_u32 v9, v42, v43
    v_sub_u32 v10, v42, v43
    v_and_b32 v42, 31, v1
    v_lshrrev_b32 v43, 3, v42
    v_and_b32 v44, 7, v42
    s_and_b32 s74, s65, 3
    s_lshl_b32 s74, s74, 6
    s_lshr_b32 s75, s65, 2
    s_add_u32 s74, s74, s75
    v_lshlrev_b32 v44, 3, v44
    v_lshl_add_u32 v44, v43, 1, v44
    v_add_u32 v11, s74, v44
    v_lshl_add_u32 v13, v42, 3, s73
    s_lshr_b32 s74, s72, 1
    s_lshr_b32 s75, s74, 2
    s_lshl_b32 s75, s75, 1
    s_and_b32 s74, s74, 3
    s_lshl_b32 s74, s74, 3
    s_add_u32 s74, s74, s75
    v_lshrrev_b32 v43, 3, v37
    v_and_b32 v44, 7, v37
    v_lshl_add_u32 v43, v44, 5, v43
    v_add_u32 v12, s74, v43
    v_lshlrev_b32 v11, 7, v11
    v_add_u32 v11, 14680064, v11
    v_lshlrev_b32 v12, 7, v12
    v_add_u32 v12, 14712832, v12
    v_lshlrev_b32 v13, 7, v13
    v_add_u32 v13, 14745600, v13
    s_lshr_b32 s74, s64, 1
    s_and_b32 s75, s64, 1
    s_mul_i32 s76, s74, 33024
    s_add_u32 s76, s76, 86016
    v_and_b32 v42, 7, v37
    v_lshrrev_b32 v43, 3, v37
    v_mul_u32_u24 v44, 4128, v42
    v_lshl_add_u32 v44, v43, 8, v44
    v_lshl_add_u32 v44, v34, 4, v44
    v_add_u32 v44, s76, v44
    s_lshl_b32 s77, s75, 8
    v_subrev_u32 v16, s77, v44
    v_lshlrev_b32 v45, 5, v42
    v_lshl_add_u32 v45, v34, 4, v45
    v_add_u32 v45, 160768, v45
    s_cmp_eq_u32 s75, 1
    s_cselect_b32 s77, 0, 1
    v_or_b32 v43, s77, v43
    v_cmp_ne_u32 vcc, 0, v43
    s_nop 1
    v_cndmask_b32 v15, v45, v16, vcc
    v_sub_u32 v42, v37, v34
    v_add_u32 v42, 3, v42
    v_lshlrev_b32 v42, 4, v42
    s_mul_i32 s76, s74, 4336
    s_lshl_b32 s77, s75, 8
    s_add_u32 s76, s76, s77
    s_add_u32 s76, s76, 152064
    v_add_u32 v17, s76, v42
    s_mul_i32 s76, s74, 33024
    s_lshl_b32 s77, s75, 11
    s_add_u32 s76, s76, s77
    s_add_u32 s76, s76, 114912
    v_lshlrev_b32 v42, 8, v41
    v_lshl_add_u32 v42, v37, 4, v42
    v_lshl_add_u32 v42, v40, 3, v42
    v_add_u32 v18, s76, v42
    v_lshlrev_b32 v42, 1, v34
    v_xor_b32 v42, v42, v33
    v_lshlrev_b32 v43, 10, v32
    v_lshl_add_u32 v19, v42, 4, v43
    v_lshlrev_b32 v43, 12, v32
    v_lshl_add_u32 v28, v42, 4, v43
    v_lshrrev_b32 v42, 1, v38
    v_lshl_add_u32 v42, v34, 1, v42
    v_and_b32 v42, 3, v42
    v_lshl_add_u32 v43, v34, 2, v38
    v_lshlrev_b32 v43, 7, v43
    v_lshl_add_u32 v43, v39, 3, v43
    s_mul_i32 s76, s64, 20480
    v_xor_b32 v44, 0, v42
    v_lshl_add_u32 v44, v44, 5, v43
    v_add_u32 v20, s76, v44
    v_xor_b32 v44, 1, v42
    v_lshl_add_u32 v44, v44, 5, v43
    v_add_u32 v21, s76, v44
    v_xor_b32 v44, 2, v42
    v_lshl_add_u32 v44, v44, 5, v43
    v_add_u32 v22, s76, v44
    v_xor_b32 v44, 3, v42
    v_lshl_add_u32 v44, v44, 5, v43
    v_add_u32 v23, s76, v44
    v_xor_b32 v44, s64, v42
    v_lshl_add_u32 v44, v44, 5, v43
    v_add_u32 v29, 151552, v44
    v_and_b32 v130, 15, v1
    v_lshrrev_b32 v131, 4, v1
    v_lshrrev_b32 v132, 2, v130
    v_and_b32 v133, 3, v1
    v_lshrrev_b32 v134, 1, v131
    v_lshlrev_b32 v134, 11, v134
    v_and_b32 v135, 1, v131
    v_lshl_add_u32 v135, v135, 3, v132
    v_lshl_add_u32 v134, v135, 7, v134
    v_lshl_add_u32 v134, v133, 3, v134
    s_lshl_b32 s74, s64, 5
    s_add_u32 s74, s74, 32768
    v_add_u32 v134, s74, v134
    s_mul_i32 s75, s64, 2304
    s_add_u32 s75, s75, 73728
    v_mul_u32_u24 v135, 144, v130
    v_lshl_add_u32 v135, v131, 4, v135
    v_add_u32 v135, s75, v135
    v_lshrrev_b32 v136, 3, v1
    v_and_b32 v137, 7, v1
    v_mul_u32_u24 v138, 144, v136
    v_lshl_add_u32 v138, v137, 4, v138
    v_add_u32 v138, s75, v138
    v_mul_u32_u24 v139, 4224, v136
    v_lshl_add_u32 v139, v137, 4, v139
    v_cmp_eq_u32 s[90:91], 0, v137
    s_lshl_b32 s74, s70, 6
    s_lshl_b32 s75, s64, 4
    s_add_u32 s74, s74, s75
    s_mul_i32 s74, s74, 4224
    s_lshl_b32 s75, s69, 7
    s_add_u32 s74, s74, s75
    s_add_u32 s87, s74, 128
    s_mul_i32 s74, s64, 18432
    s_add_u32 s74, s74, 86016
    v_lshl_add_u32 v54, v1, 2, s74
    s_mov_b32 s92, 0x3fb8aa3b
    s_mov_b32 s93, 0x32a57060
    s_mov_b32 s94, 0x3e22f983
    s_mov_b32 s95, 0x3f317218
    s_waitcnt vmcnt(18)
    v_lshlrev_b32 v46, 16, v46
    v_lshlrev_b32 v47, 16, v47
    v_lshlrev_b32 v48, 16, v48
    v_lshlrev_b32 v49, 16, v49
    v_lshlrev_b32 v50, 16, v50
    v_lshlrev_b32 v51, 16, v51
    v_lshlrev_b32 v52, 16, v52
    v_lshlrev_b32 v53, 16, v53
    v_mov_b32 v24, v53
    v_mul_f32 v56, s92, v52
    v_fma_f32 v57, v52, s92, -v56
    v_fma_f32 v57, v52, s93, v57
    v_exp_f32 v56, v56
    v_mul_f32 v57, s95, v57
    v_fma_f32 v56, v56, v57, v56
    v_cvt_pk_bf16_f32 v56, v56, v56
    v_lshlrev_b32 v56, 16, v56
    v_mul_f32 v46, v56, v46
    v_mul_f32 v47, v56, v47
    v_mul_f32 v48, v56, v48
    v_mul_f32 v49, v56, v49
    v_mul_f32 v46, s92, v46
    v_mul_f32 v47, s94, v47
    v_pk_mul_f32 v[58:59], v[50:51], v[48:49] op_sel:[0,0] op_sel_hi:[0,1]
    v_pk_fma_f32 v[58:59], v[50:51], v[48:49], v[58:59] op_sel:[1,1,0] op_sel_hi:[1,0,1] neg_lo:[1,0,0]
    v_mov_b32 v100, v46
    v_fract_f32 v101, v47
    v_mul_f32 v104, 0x41000000, v46
    v_mul_f32 v105, 0x41000000, v47
    v_fract_f32 v105, v105
    v_mul_f32 v108, 0x43000000, v46
    v_mul_f32 v109, 0x43000000, v47
    v_fract_f32 v109, v109
    v_exp_f32 v100, v100
    v_exp_f32 v104, v104
    v_exp_f32 v108, v108
    v_cos_f32 v102, v101
    v_cos_f32 v106, v105
    v_cos_f32 v110, v109
    v_sin_f32 v103, v101
    v_sin_f32 v107, v105
    v_sin_f32 v111, v109
    v_mul_f32 v60, v100, v102
    v_mul_f32 v61, v100, v103
    v_mul_f32 v62, v104, v106
    v_mul_f32 v63, v104, v107
    v_mul_f32 v64, v108, v110
    v_mul_f32 v65, v108, v111
    v_mov_b32 v116, 0x3f80
    ds_write_b32 v54, v116 offset:13824
    v_cvt_pk_bf16_f32 v112, v58, -v59
    ds_write_b32 v54, v112 offset:0
    v_cvt_pk_bf16_f32 v113, v62, v63
    ds_write_b32 v54, v113 offset:14112
    s_waitcnt vmcnt(16)
    s_barrier
    ds_read_b64_tr_b16 v[140:141], v134 offset:0
    ds_read_b64_tr_b16 v[142:143], v134 offset:512
    ds_read_b64_tr_b16 v[144:145], v134 offset:4096
    ds_read_b64_tr_b16 v[146:147], v134 offset:4608
    v_pk_mul_f32 v[66:67], v[60:61], v[60:61] op_sel:[0,0] op_sel_hi:[0,1]
    v_pk_mul_f32 v[78:79], v[62:63], v[62:63] op_sel:[0,0] op_sel_hi:[0,1]
    v_pk_fma_f32 v[66:67], v[60:61], v[60:61], v[66:67] op_sel:[1,1,0] op_sel_hi:[1,0,1] neg_lo:[1,0,0]
    v_pk_fma_f32 v[78:79], v[62:63], v[62:63], v[78:79] op_sel:[1,1,0] op_sel_hi:[1,0,1] neg_lo:[1,0,0]
    v_pk_mul_f32 v[68:69], v[66:67], v[60:61] op_sel:[0,0] op_sel_hi:[0,1]
    v_pk_mul_f32 v[70:71], v[66:67], v[66:67] op_sel:[0,0] op_sel_hi:[0,1]
    v_pk_fma_f32 v[68:69], v[66:67], v[60:61], v[68:69] op_sel:[1,1,0] op_sel_hi:[1,0,1] neg_lo:[1,0,0]
    v_pk_fma_f32 v[70:71], v[66:67], v[66:67], v[70:71] op_sel:[1,1,0] op_sel_hi:[1,0,1] neg_lo:[1,0,0]
    v_pk_mul_f32 v[80:81], v[78:79], v[62:63] op_sel:[0,0] op_sel_hi:[0,1]
    v_pk_mul_f32 v[82:83], v[78:79], v[78:79] op_sel:[0,0] op_sel_hi:[0,1]
    v_pk_fma_f32 v[80:81], v[78:79], v[62:63], v[80:81] op_sel:[1,1,0] op_sel_hi:[1,0,1] neg_lo:[1,0,0]
    v_pk_fma_f32 v[82:83], v[78:79], v[78:79], v[82:83] op_sel:[1,1,0] op_sel_hi:[1,0,1] neg_lo:[1,0,0]
    v_cvt_pk_bf16_f32 v114, v78, v79
    ds_write_b32 v54, v114 offset:14400
    v_pk_mul_f32 v[72:73], v[70:71], v[60:61] op_sel:[0,0] op_sel_hi:[0,1]
    v_pk_mul_f32 v[74:75], v[70:71], v[66:67] op_sel:[0,0] op_sel_hi:[0,1]
    v_pk_fma_f32 v[72:73], v[70:71], v[60:61], v[72:73] op_sel:[1,1,0] op_sel_hi:[1,0,1] neg_lo:[1,0,0]
    v_pk_fma_f32 v[74:75], v[70:71], v[66:67], v[74:75] op_sel:[1,1,0] op_sel_hi:[1,0,1] neg_lo:[1,0,0]
    v_cvt_pk_bf16_f32 v115, v80, v81
    ds_write_b32 v54, v115 offset:14688
    v_cvt_pk_bf16_f32 v112, v82, v83
    ds_write_b32 v54, v112 offset:14976
    v_pk_mul_f32 v[76:77], v[70:71], v[68:69] op_sel:[0,0] op_sel_hi:[0,1]
    v_pk_mul_f32 v[84:85], v[58:59], v[64:65] op_sel:[0,0] op_sel_hi:[0,1]
    v_pk_fma_f32 v[76:77], v[70:71], v[68:69], v[76:77] op_sel:[1,1,0] op_sel_hi:[1,0,1] neg_lo:[1,0,0]
    v_pk_fma_f32 v[84:85], v[58:59], v[64:65], v[84:85] op_sel:[1,1,0] op_sel_hi:[1,0,1] neg_lo:[1,0,0]
    v_pk_mul_f32 v[86:87], v[58:59], v[60:61] op_sel:[0,0] op_sel_hi:[0,1]
    v_pk_mul_f32 v[88:89], v[58:59], v[66:67] op_sel:[0,0] op_sel_hi:[0,1]
    v_pk_fma_f32 v[86:87], v[58:59], v[60:61], v[86:87] op_sel:[1,1,0] op_sel_hi:[1,0,1] neg_lo:[1,0,0]
    v_pk_fma_f32 v[88:89], v[58:59], v[66:67], v[88:89] op_sel:[1,1,0] op_sel_hi:[1,0,1] neg_lo:[1,0,0]
    v_cvt_pk_bf16_f32 v113, v86, -v87
    ds_write_b32 v54, v113 offset:288
    v_cvt_pk_bf16_f32 v114, v88, -v89
    ds_write_b32 v54, v114 offset:576
    s_waitcnt lgkmcnt(5)
    ds_write_b128 v135, v[140:143] offset:0
    ds_write_b128 v135, v[144:147] offset:64
    v_pk_mul_f32 v[86:87], v[58:59], v[68:69] op_sel:[0,0] op_sel_hi:[0,1]
    v_pk_mul_f32 v[88:89], v[58:59], v[70:71] op_sel:[0,0] op_sel_hi:[0,1]
    v_pk_fma_f32 v[86:87], v[58:59], v[68:69], v[86:87] op_sel:[1,1,0] op_sel_hi:[1,0,1] neg_lo:[1,0,0]
    v_pk_fma_f32 v[88:89], v[58:59], v[70:71], v[88:89] op_sel:[1,1,0] op_sel_hi:[1,0,1] neg_lo:[1,0,0]
    v_cvt_pk_bf16_f32 v115, v86, -v87
    ds_write_b32 v54, v115 offset:864
    v_cvt_pk_bf16_f32 v112, v88, -v89
    ds_write_b32 v54, v112 offset:1152
    v_pk_mul_f32 v[86:87], v[58:59], v[72:73] op_sel:[0,0] op_sel_hi:[0,1]
    v_pk_mul_f32 v[88:89], v[58:59], v[74:75] op_sel:[0,0] op_sel_hi:[0,1]
    v_pk_fma_f32 v[86:87], v[58:59], v[72:73], v[86:87] op_sel:[1,1,0] op_sel_hi:[1,0,1] neg_lo:[1,0,0]
    v_pk_fma_f32 v[88:89], v[58:59], v[74:75], v[88:89] op_sel:[1,1,0] op_sel_hi:[1,0,1] neg_lo:[1,0,0]
    v_cvt_pk_bf16_f32 v113, v86, -v87
    ds_write_b32 v54, v113 offset:1440
    v_cvt_pk_bf16_f32 v114, v88, -v89
    ds_write_b32 v54, v114 offset:1728
    v_pk_mul_f32 v[86:87], v[58:59], v[76:77] op_sel:[0,0] op_sel_hi:[0,1]
    v_pk_mul_f32 v[118:119], v[62:63], v[82:83] op_sel:[0,0] op_sel_hi:[0,1]
    v_pk_fma_f32 v[86:87], v[58:59], v[76:77], v[86:87] op_sel:[1,1,0] op_sel_hi:[1,0,1] neg_lo:[1,0,0]
    v_pk_fma_f32 v[118:119], v[62:63], v[82:83], v[118:119] op_sel:[1,1,0] op_sel_hi:[1,0,1] neg_lo:[1,0,0]
    v_cvt_pk_bf16_f32 v115, v118, v119
    ds_write_b32 v54, v115 offset:15264
    s_waitcnt lgkmcnt(5)
    ds_read_b128 v[148:151], v138 offset:0
    ds_read_b128 v[152:155], v138 offset:1152
    v_cvt_pk_bf16_f32 v112, v86, -v87
    ds_write_b32 v54, v112 offset:2016
    v_cvt_pk_bf16_f32 v113, v84, -v85
    ds_write_b32 v54, v113 offset:2304
    v_pk_mul_f32 v[86:87], v[84:85], v[60:61] op_sel:[0,0] op_sel_hi:[0,1]
    v_pk_mul_f32 v[88:89], v[84:85], v[66:67] op_sel:[0,0] op_sel_hi:[0,1]
    v_pk_fma_f32 v[86:87], v[84:85], v[60:61], v[86:87] op_sel:[1,1,0] op_sel_hi:[1,0,1] neg_lo:[1,0,0]
    v_pk_fma_f32 v[88:89], v[84:85], v[66:67], v[88:89] op_sel:[1,1,0] op_sel_hi:[1,0,1] neg_lo:[1,0,0]
    v_cvt_pk_bf16_f32 v114, v86, -v87
    ds_write_b32 v54, v114 offset:2592
    v_cvt_pk_bf16_f32 v115, v88, -v89
    ds_write_b32 v54, v115 offset:2880
    v_pk_mul_f32 v[86:87], v[84:85], v[68:69] op_sel:[0,0] op_sel_hi:[0,1]
    v_pk_mul_f32 v[88:89], v[84:85], v[70:71] op_sel:[0,0] op_sel_hi:[0,1]
    v_pk_fma_f32 v[86:87], v[84:85], v[68:69], v[86:87] op_sel:[1,1,0] op_sel_hi:[1,0,1] neg_lo:[1,0,0]
    v_pk_fma_f32 v[88:89], v[84:85], v[70:71], v[88:89] op_sel:[1,1,0] op_sel_hi:[1,0,1] neg_lo:[1,0,0]
    v_cvt_pk_bf16_f32 v112, v86, -v87
    ds_write_b32 v54, v112 offset:3168
    s_waitcnt vmcnt(14)
    s_waitcnt lgkmcnt(6)
    s_add_u32 s75, s87, 0
    buffer_store_dwordx4 v[148:151], v139, s[48:51], s75 offen sc1
    v_mov_b32_dpp v164, v151 row_shr:1 row_mask:0xf bank_mask:0xf
    s_nop 0
    v_cndmask_b32 v164, v164, v172, s[90:91]
    v_alignbit_b32 v156, v148, v164, 16
    v_alignbit_b32 v157, v149, v148, 16
    v_alignbit_b32 v158, v150, v149, 16
    v_alignbit_b32 v159, v151, v150, 16
    s_add_u32 s75, s87, 2228224
    buffer_store_dwordx4 v[156:159], v139, s[48:51], s75 offen sc1
    s_waitcnt lgkmcnt(5)
    s_add_u32 s75, s87, 33792
    buffer_store_dwordx4 v[152:155], v139, s[48:51], s75 offen sc1
    v_mov_b32_dpp v164, v155 row_shr:1 row_mask:0xf bank_mask:0xf
    s_nop 0
    v_cndmask_b32 v164, v164, v173, s[90:91]
    v_alignbit_b32 v160, v152, v164, 16
    v_alignbit_b32 v161, v153, v152, 16
    v_alignbit_b32 v162, v154, v153, 16
    v_alignbit_b32 v163, v155, v154, 16
    s_add_u32 s75, s87, 2262016
    buffer_store_dwordx4 v[160:163], v139, s[48:51], s75 offen sc1
    s_cmp_lg_u32 s69, 0
    s_cbranch_scc1 TZ_2
    s_mov_b64 exec, s[90:91]
    v_mov_b32 v168, 0
    v_mov_b32 v169, 0
    v_mov_b32 v170, 0
    v_mov_b32 v171, 0
    s_add_u32 s75, s87, -16
    buffer_store_dwordx4 v[168:171], v139, s[48:51], s75 offen sc1
    s_add_u32 s75, s87, 33776
    buffer_store_dwordx4 v[168:171], v139, s[48:51], s75 offen sc1
    s_add_u32 s75, s87, 2228208
    buffer_store_dwordx4 v[168:171], v139, s[48:51], s75 offen sc1
    s_add_u32 s75, s87, 2262000
    buffer_store_dwordx4 v[168:171], v139, s[48:51], s75 offen sc1
    s_mov_b64 exec, -1
TZ_2:
    v_cvt_pk_bf16_f32 v113, v88, -v89
    ds_write_b32 v54, v113 offset:3456
    v_pk_mul_f32 v[86:87], v[84:85], v[72:73] op_sel:[0,0] op_sel_hi:[0,1]
    v_pk_mul_f32 v[88:89], v[84:85], v[74:75] op_sel:[0,0] op_sel_hi:[0,1]
    v_pk_fma_f32 v[86:87], v[84:85], v[72:73], v[86:87] op_sel:[1,1,0] op_sel_hi:[1,0,1] neg_lo:[1,0,0]
    v_pk_fma_f32 v[88:89], v[84:85], v[74:75], v[88:89] op_sel:[1,1,0] op_sel_hi:[1,0,1] neg_lo:[1,0,0]
    v_cvt_pk_bf16_f32 v114, v86, -v87
    ds_write_b32 v54, v114 offset:3744
    buffer_load_dwordx2 v[26:27], off, s[56:59], 0 sc1
    v_cvt_pk_bf16_f32 v115, v88, -v89
    ds_write_b32 v54, v115 offset:4032
    v_pk_mul_f32 v[86:87], v[84:85], v[76:77] op_sel:[0,0] op_sel_hi:[0,1]
    v_pk_mul_f32 v[120:121], v[78:79], v[82:83] op_sel:[0,0] op_sel_hi:[0,1]
    v_pk_fma_f32 v[86:87], v[84:85], v[76:77], v[86:87] op_sel:[1,1,0] op_sel_hi:[1,0,1] neg_lo:[1,0,0]
    v_pk_fma_f32 v[120:121], v[78:79], v[82:83], v[120:121] op_sel:[1,1,0] op_sel_hi:[1,0,1] neg_lo:[1,0,0]
    v_cvt_pk_bf16_f32 v112, v120, v121
    ds_write_b32 v54, v112 offset:15552
    v_cvt_pk_bf16_f32 v113, v86, -v87
    ds_write_b32 v54, v113 offset:4320
    v_pk_mul_f32 v[94:95], v[84:85], v[64:65] op_sel:[0,0] op_sel_hi:[0,1]
    v_pk_mul_f32 v[122:123], v[80:81], v[82:83] op_sel:[0,0] op_sel_hi:[0,1]
    v_pk_fma_f32 v[94:95], v[84:85], v[64:65], v[94:95] op_sel:[1,1,0] op_sel_hi:[1,0,1] neg_lo:[1,0,0]
    v_pk_fma_f32 v[122:123], v[80:81], v[82:83], v[122:123] op_sel:[1,1,0] op_sel_hi:[1,0,1] neg_lo:[1,0,0]
    v_cvt_pk_bf16_f32 v114, v122, v123
    ds_write_b32 v54, v114 offset:15840
    v_cvt_pk_bf16_f32 v115, v94, -v95
    ds_write_b32 v54, v115 offset:4608
    v_pk_mul_f32 v[86:87], v[94:95], v[66:67] op_sel:[0,0] op_sel_hi:[0,1]
    v_pk_mul_f32 v[88:89], v[94:95], v[70:71] op_sel:[0,0] op_sel_hi:[0,1]
    v_pk_fma_f32 v[86:87], v[94:95], v[66:67], v[86:87] op_sel:[1,1,0] op_sel_hi:[1,0,1] neg_lo:[1,0,0]
    v_pk_fma_f32 v[88:89], v[94:95], v[70:71], v[88:89] op_sel:[1,1,0] op_sel_hi:[1,0,1] neg_lo:[1,0,0]
    v_cvt_pk_bf16_f32 v112, v86, -v87
    ds_write_b32 v54, v112 offset:4896
    v_cvt_pk_bf16_f32 v113, v88, -v89
    ds_write_b32 v54, v113 offset:5184
    v_pk_mul_f32 v[86:87], v[94:95], v[74:75] op_sel:[0,0] op_sel_hi:[0,1]
    v_pk_mul_f32 v[124:125], v[82:83], v[82:83] op_sel:[0,0] op_sel_hi:[0,1]
    v_pk_fma_f32 v[86:87], v[94:95], v[74:75], v[86:87] op_sel:[1,1,0] op_sel_hi:[1,0,1] neg_lo:[1,0,0]
    v_pk_fma_f32 v[124:125], v[82:83], v[82:83], v[124:125] op_sel:[1,1,0] op_sel_hi:[1,0,1] neg_lo:[1,0,0]
    v_cvt_pk_bf16_f32 v114, v124, v125
    ds_write_b32 v54, v114 offset:16128
    v_cvt_pk_bf16_f32 v115, v86, -v87
    ds_write_b32 v54, v115 offset:5472
    v_pk_mul_f32 v[90:91], v[94:95], v[64:65] op_sel:[0,0] op_sel_hi:[0,1]
    v_pk_mul_f32 v[126:127], v[118:119], v[82:83] op_sel:[0,0] op_sel_hi:[0,1]
    v_pk_fma_f32 v[90:91], v[94:95], v[64:65], v[90:91] op_sel:[1,1,0] op_sel_hi:[1,0,1] neg_lo:[1,0,0]
    v_pk_fma_f32 v[126:127], v[118:119], v[82:83], v[126:127] op_sel:[1,1,0] op_sel_hi:[1,0,1] neg_lo:[1,0,0]
    v_cvt_pk_bf16_f32 v112, v126, v127
    ds_write_b32 v54, v112 offset:16416
    v_cvt_pk_bf16_f32 v113, v90, -v91
    ds_write_b32 v54, v113 offset:5760
    v_pk_mul_f32 v[86:87], v[90:91], v[66:67] op_sel:[0,0] op_sel_hi:[0,1]
    v_pk_mul_f32 v[88:89], v[90:91], v[70:71] op_sel:[0,0] op_sel_hi:[0,1]
    v_pk_fma_f32 v[86:87], v[90:91], v[66:67], v[86:87] op_sel:[1,1,0] op_sel_hi:[1,0,1] neg_lo:[1,0,0]
    v_pk_fma_f32 v[88:89], v[90:91], v[70:71], v[88:89] op_sel:[1,1,0] op_sel_hi:[1,0,1] neg_lo:[1,0,0]
    v_cvt_pk_bf16_f32 v114, v86, -v87
    ds_write_b32 v54, v114 offset:6048
    v_cvt_pk_bf16_f32 v115, v88, -v89
    ds_write_b32 v54, v115 offset:6336
    v_pk_mul_f32 v[86:87], v[90:91], v[74:75] op_sel:[0,0] op_sel_hi:[0,1]
    v_pk_mul_f32 v[118:119], v[120:121], v[82:83] op_sel:[0,0] op_sel_hi:[0,1]
    v_pk_fma_f32 v[86:87], v[90:91], v[74:75], v[86:87] op_sel:[1,1,0] op_sel_hi:[1,0,1] neg_lo:[1,0,0]
    v_pk_fma_f32 v[118:119], v[120:121], v[82:83], v[118:119] op_sel:[1,1,0] op_sel_hi:[1,0,1] neg_lo:[1,0,0]
    v_cvt_pk_bf16_f32 v112, v118, v119
    ds_write_b32 v54, v112 offset:16704
    s_barrier
    v_cvt_pk_bf16_f32 v113, v86, -v87
    ds_write_b32 v54, v113 offset:6624
    s_add_u32 m0, s23, 32768
    s_add_u32 s18, s19, 2
    s_and_b32 s18, s18, 7
    s_lshl_b32 s22, s18, 7
    s_add_u32 s22, s22, s80
    v_pk_mul_f32 v[92:93], v[90:91], v[64:65] op_sel:[0,0] op_sel_hi:[0,1]
    v_pk_mul_f32 v[120:121], v[122:123], v[82:83] op_sel:[0,0] op_sel_hi:[0,1]
    v_pk_fma_f32 v[92:93], v[90:91], v[64:65], v[92:93] op_sel:[1,1,0] op_sel_hi:[1,0,1] neg_lo:[1,0,0]
    v_pk_fma_f32 v[120:121], v[122:123], v[82:83], v[120:121] op_sel:[1,1,0] op_sel_hi:[1,0,1] neg_lo:[1,0,0]
    v_cvt_pk_bf16_f32 v114, v120, v121
    ds_write_b32 v54, v114 offset:16992
    buffer_load_dwordx4 v2, s[36:39], s22 offen lds
    v_cvt_pk_bf16_f32 v115, v92, -v93
    ds_write_b32 v54, v115 offset:6912
    v_pk_mul_f32 v[86:87], v[92:93], v[70:71] op_sel:[0,0] op_sel_hi:[0,1]
    v_pk_mul_f32 v[122:123], v[124:125], v[82:83] op_sel:[0,0] op_sel_hi:[0,1]
    v_pk_fma_f32 v[86:87], v[92:93], v[70:71], v[86:87] op_sel:[1,1,0] op_sel_hi:[1,0,1] neg_lo:[1,0,0]
    v_pk_fma_f32 v[122:123], v[124:125], v[82:83], v[122:123] op_sel:[1,1,0] op_sel_hi:[1,0,1] neg_lo:[1,0,0]
    v_cvt_pk_bf16_f32 v112, v122, v123
    ds_write_b32 v54, v112 offset:17280
    buffer_load_dwordx4 v3, s[36:39], s22 offen offset:1024 lds
    v_cvt_pk_bf16_f32 v113, v86, -v87
    ds_write_b32 v54, v113 offset:7200
    v_pk_mul_f32 v[94:95], v[92:93], v[64:65] op_sel:[0,0] op_sel_hi:[0,1]
    v_pk_mul_f32 v[124:125], v[126:127], v[82:83] op_sel:[0,0] op_sel_hi:[0,1]
    v_pk_fma_f32 v[94:95], v[92:93], v[64:65], v[94:95] op_sel:[1,1,0] op_sel_hi:[1,0,1] neg_lo:[1,0,0]
    v_pk_fma_f32 v[124:125], v[126:127], v[82:83], v[124:125] op_sel:[1,1,0] op_sel_hi:[1,0,1] neg_lo:[1,0,0]
    v_cvt_pk_bf16_f32 v114, v124, v125
    ds_write_b32 v54, v114 offset:17568
    buffer_load_dwordx4 v30, s[36:39], s22 offen offset:2048 lds
    v_cvt_pk_bf16_f32 v115, v94, -v95
    ds_write_b32 v54, v115 offset:7488
    v_pk_mul_f32 v[86:87], v[94:95], v[70:71] op_sel:[0,0] op_sel_hi:[0,1]
    v_pk_mul_f32 v[126:127], v[118:119], v[82:83] op_sel:[0,0] op_sel_hi:[0,1]
    v_pk_fma_f32 v[86:87], v[94:95], v[70:71], v[86:87] op_sel:[1,1,0] op_sel_hi:[1,0,1] neg_lo:[1,0,0]
    v_pk_fma_f32 v[126:127], v[118:119], v[82:83], v[126:127] op_sel:[1,1,0] op_sel_hi:[1,0,1] neg_lo:[1,0,0]
    v_cvt_pk_bf16_f32 v112, v126, v127
    ds_write_b32 v54, v112 offset:17856
    buffer_load_dwordx4 v25, s[36:39], s22 offen offset:3072 lds
    v_cvt_pk_bf16_f32 v113, v86, -v87
    ds_write_b32 v54, v113 offset:7776
    s_add_u32 m0, s3, 73728
    s_mul_i32 s21, s18, 176128
    s_add_u32 s21, s21, s81
    v_pk_mul_f32 v[90:91], v[94:95], v[64:65] op_sel:[0,0] op_sel_hi:[0,1]
    v_pk_mul_f32 v[118:119], v[120:121], v[82:83] op_sel:[0,0] op_sel_hi:[0,1]
    v_pk_fma_f32 v[90:91], v[94:95], v[64:65], v[90:91] op_sel:[1,1,0] op_sel_hi:[1,0,1] neg_lo:[1,0,0]
    v_pk_fma_f32 v[118:119], v[120:121], v[82:83], v[118:119] op_sel:[1,1,0] op_sel_hi:[1,0,1] neg_lo:[1,0,0]
    v_cvt_pk_bf16_f32 v114, v118, v119
    ds_write_b32 v54, v114 offset:18144
    buffer_load_dwordx4 v4, s[40:43], s21 offen lds
    v_cvt_pk_bf16_f32 v115, v90, -v91
    ds_write_b32 v54, v115 offset:8064
    v_pk_mul_f32 v[86:87], v[90:91], v[70:71] op_sel:[0,0] op_sel_hi:[0,1]
    v_pk_fma_f32 v[86:87], v[90:91], v[70:71], v[86:87] op_sel:[1,1,0] op_sel_hi:[1,0,1] neg_lo:[1,0,0]
    v_cvt_pk_bf16_f32 v112, v86, -v87
    ds_write_b32 v54, v112 offset:8352
    buffer_load_dwordx4 v5, s[40:43], s21 offen offset:1024 lds
    v_pk_mul_f32 v[92:93], v[90:91], v[64:65] op_sel:[0,0] op_sel_hi:[0,1]
    v_pk_fma_f32 v[92:93], v[90:91], v[64:65], v[92:93] op_sel:[1,1,0] op_sel_hi:[1,0,1] neg_lo:[1,0,0]
    v_cvt_pk_bf16_f32 v113, v92, -v93
    ds_write_b32 v54, v113 offset:8640
    v_pk_mul_f32 v[86:87], v[92:93], v[70:71] op_sel:[0,0] op_sel_hi:[0,1]
    v_pk_fma_f32 v[86:87], v[92:93], v[70:71], v[86:87] op_sel:[1,1,0] op_sel_hi:[1,0,1] neg_lo:[1,0,0]
    v_cvt_pk_bf16_f32 v114, v86, -v87
    ds_write_b32 v54, v114 offset:8928
    buffer_load_dwordx4 v6, s[40:43], s21 offen offset:2048 lds
    v_pk_mul_f32 v[94:95], v[92:93], v[64:65] op_sel:[0,0] op_sel_hi:[0,1]
    v_pk_fma_f32 v[94:95], v[92:93], v[64:65], v[94:95] op_sel:[1,1,0] op_sel_hi:[1,0,1] neg_lo:[1,0,0]
    v_cvt_pk_bf16_f32 v115, v94, -v95
    ds_write_b32 v54, v115 offset:9216
    v_pk_mul_f32 v[90:91], v[94:95], v[64:65] op_sel:[0,0] op_sel_hi:[0,1]
    v_pk_fma_f32 v[90:91], v[94:95], v[64:65], v[90:91] op_sel:[1,1,0] op_sel_hi:[1,0,1] neg_lo:[1,0,0]
    v_cvt_pk_bf16_f32 v112, v90, -v91
    ds_write_b32 v54, v112 offset:9504
    v_pk_mul_f32 v[92:93], v[90:91], v[64:65] op_sel:[0,0] op_sel_hi:[0,1]
    v_pk_fma_f32 v[92:93], v[90:91], v[64:65], v[92:93] op_sel:[1,1,0] op_sel_hi:[1,0,1] neg_lo:[1,0,0]
    v_cvt_pk_bf16_f32 v113, v92, -v93
    ds_write_b32 v54, v113 offset:9792
    s_and_b32 s100, s66, 7
    s_mul_i32 s100, s100, 172
    s_mul_i32 s101, s64, 43
    s_add_u32 s100, s100, s101
    s_lshl_b32 s100, s100, 10
    s_lshl_b32 s101, s73, 7
    s_add_u32 s100, s100, s101
    v_lshlrev_b32 v228, 10, v1
    s_add_u32 s101, s100, 0
    s_mov_b32 exec_lo, 4194303
    s_mov_b32 exec_hi, 0
    buffer_load_dword v226, v228, s[44:47], s101 offen
    s_mov_b64 exec, -1
    v_pk_mul_f32 v[94:95], v[92:93], v[64:65] op_sel:[0,0] op_sel_hi:[0,1]
    v_pk_fma_f32 v[94:95], v[92:93], v[64:65], v[94:95] op_sel:[1,1,0] op_sel_hi:[1,0,1] neg_lo:[1,0,0]
    v_cvt_pk_bf16_f32 v114, v94, -v95
    ds_write_b32 v54, v114 offset:10080
    v_pk_mul_f32 v[90:91], v[94:95], v[64:65] op_sel:[0,0] op_sel_hi:[0,1]
    v_pk_fma_f32 v[90:91], v[94:95], v[64:65], v[90:91] op_sel:[1,1,0] op_sel_hi:[1,0,1] neg_lo:[1,0,0]
    v_cvt_pk_bf16_f32 v115, v90, -v91
    ds_write_b32 v54, v115 offset:10368
    v_pk_mul_f32 v[92:93], v[90:91], v[64:65] op_sel:[0,0] op_sel_hi:[0,1]
    v_pk_fma_f32 v[92:93], v[90:91], v[64:65], v[92:93] op_sel:[1,1,0] op_sel_hi:[1,0,1] neg_lo:[1,0,0]
    v_cvt_pk_bf16_f32 v112, v92, -v93
    ds_write_b32 v54, v112 offset:10656
    v_pk_mul_f32 v[94:95], v[92:93], v[64:65] op_sel:[0,0] op_sel_hi:[0,1]
    v_pk_fma_f32 v[94:95], v[92:93], v[64:65], v[94:95] op_sel:[1,1,0] op_sel_hi:[1,0,1] neg_lo:[1,0,0]
    v_cvt_pk_bf16_f32 v113, v94, -v95
    ds_write_b32 v54, v113 offset:10944
    v_pk_mul_f32 v[90:91], v[94:95], v[64:65] op_sel:[0,0] op_sel_hi:[0,1]
    v_pk_fma_f32 v[90:91], v[94:95], v[64:65], v[90:91] op_sel:[1,1,0] op_sel_hi:[1,0,1] neg_lo:[1,0,0]
    v_cvt_pk_bf16_f32 v114, v90, -v91
    ds_write_b32 v54, v114 offset:11232
    s_add_u32 s101, s100, 22528
    s_mov_b32 exec_lo, 2097151
    s_mov_b32 exec_hi, 0
    buffer_load_dword v226, v228, s[44:47], s101 offen
    s_mov_b64 exec, -1
    v_pk_mul_f32 v[92:93], v[90:91], v[64:65] op_sel:[0,0] op_sel_hi:[0,1]
    v_pk_fma_f32 v[92:93], v[90:91], v[64:65], v[92:93] op_sel:[1,1,0] op_sel_hi:[1,0,1] neg_lo:[1,0,0]
    v_cvt_pk_bf16_f32 v115, v92, -v93
    ds_write_b32 v54, v115 offset:11520
    v_and_b32 v100, 15, v1
    v_lshrrev_b32 v101, 4, v1
    s_lshr_b32 s74, s64, 1
    s_and_b32 s75, s64, 1
    s_mul_i32 s76, s74, 36864
    s_add_u32 s76, s76, 86016
    v_mul_u32_u24 v102, 288, v100
    v_lshl_add_u32 v102, v101, 4, v102
    v_add_u32 v102, s76, v102
    v_add_u32 v103, 13824, v102
    s_mul_i32 s77, s75, 4608
    v_add_u32 v102, s77, v102
    s_mul_i32 s76, s74, 1536
    s_lshl_b32 s77, s75, 5
    s_add_u32 s76, s76, s77
    s_add_u32 s76, s76, 160768
    v_mul_u32_u24 v104, 96, v100
    v_lshl_add_u32 v104, v101, 3, v104
    v_add_u32 v104, s76, v104
    s_waitcnt lgkmcnt(0)
    s_barrier
    ds_read_b128 v[128:131], v103 offset:0
    ds_read_b128 v[132:135], v102 offset:0
    ds_read_b128 v[136:139], v102 offset:4608
    ds_read_b128 v[140:143], v103 offset:64
    ds_read_b128 v[144:147], v102 offset:64
    ds_read_b128 v[148:151], v102 offset:4672
    ds_read_b128 v[152:155], v103 offset:128
    ds_read_b128 v[156:159], v102 offset:128
    ds_read_b128 v[160:163], v102 offset:4736
    ds_read_b128 v[164:167], v103 offset:192
    ds_read_b128 v[168:171], v102 offset:192
    ds_read_b128 v[172:175], v102 offset:4800
    ds_read_b128 v[176:179], v103 offset:18432
    ds_read_b128 v[180:183], v102 offset:18432
    ds_read_b128 v[184:187], v102 offset:23040
    ds_read_b128 v[188:191], v103 offset:18496
    ds_read_b128 v[192:195], v102 offset:18496
    ds_read_b128 v[196:199], v102 offset:23104
    ds_read_b128 v[200:203], v103 offset:18560
    ds_read_b128 v[204:207], v102 offset:18560
    ds_read_b128 v[208:211], v102 offset:23168
    ds_read_b128 v[212:215], v103 offset:18624
    ds_read_b128 v[216:219], v102 offset:18624
    ds_read_b128 v[220:223], v102 offset:23232
    s_waitcnt lgkmcnt(15)
    v_mfma_f32_16x16x32_bf16 v[112:115], v[132:135], v[128:131], 0
    v_mfma_f32_16x16x32_bf16 v[116:119], v[136:139], v[128:131], 0
    v_mfma_f32_16x16x32_bf16 v[112:115], v[144:147], v[140:143], v[112:115]
    v_mfma_f32_16x16x32_bf16 v[116:119], v[148:151], v[140:143], v[116:119]
    v_mfma_f32_16x16x32_bf16 v[112:115], v[156:159], v[152:155], v[112:115]
    v_mfma_f32_16x16x32_bf16 v[116:119], v[160:163], v[152:155], v[116:119]
    s_waitcnt lgkmcnt(12)
    v_mfma_f32_16x16x32_bf16 v[112:115], v[168:171], v[164:167], v[112:115]
    v_mfma_f32_16x16x32_bf16 v[116:119], v[172:175], v[164:167], v[116:119]
    s_waitcnt lgkmcnt(9)
    v_mfma_f32_16x16x32_bf16 v[112:115], v[180:183], v[176:179], v[112:115]
    v_mfma_f32_16x16x32_bf16 v[116:119], v[184:187], v[176:179], v[116:119]
    s_waitcnt lgkmcnt(6)
    v_mfma_f32_16x16x32_bf16 v[112:115], v[192:195], v[188:191], v[112:115]
    v_mfma_f32_16x16x32_bf16 v[116:119], v[196:199], v[188:191], v[116:119]
    s_waitcnt lgkmcnt(3)
    v_mfma_f32_16x16x32_bf16 v[112:115], v[204:207], v[200:203], v[112:115]
    v_mfma_f32_16x16x32_bf16 v[116:119], v[208:211], v[200:203], v[116:119]
    s_waitcnt lgkmcnt(0)
    v_mfma_f32_16x16x32_bf16 v[112:115], v[216:219], v[212:215], v[112:115]
    v_mfma_f32_16x16x32_bf16 v[116:119], v[220:223], v[212:215], v[116:119]
    s_nop 6
    v_cvt_pk_bf16_f32 v120, v112, v113
    v_cvt_pk_bf16_f32 v121, v114, v115
    ds_write_b64 v104, v[120:121] offset:0
    v_cvt_pk_bf16_f32 v122, v116, v117
    v_cvt_pk_bf16_f32 v123, v118, v119
    ds_write_b64 v104, v[122:123] offset:32
    v_and_b32 v104, 15, v0
    v_mul_u32_u24 v104, 96, v104
    v_lshrrev_b32 v105, 4, v0
    v_add_u32 v106, 1, v0
    v_and_b32 v107, 15, v106
    v_mul_u32_u24 v107, 96, v107
    v_lshrrev_b32 v106, 4, v106
    v_lshlrev_b32 v108, 4, v0
    v_add_u32 v108, 152304, v108
    v_add_u32 v104, 160768, v104
    v_add_u32 v107, 160768, v107
    s_waitcnt lgkmcnt(0)
    s_waitcnt vmcnt(9)
    v_cmp_eq_u64 vcc, 0, v[26:27]
    s_cbranch_vccz NOND_4
    s_mov_b32 s86, 4000
NON_3:
    s_sleep 2
    buffer_load_dwordx2 v[26:27], off, s[56:59], 0 sc1
    s_waitcnt vmcnt(0)
    v_cmp_eq_u64 vcc, 0, v[26:27]
    s_cbranch_vccz NOND_4
    s_sub_u32 s86, s86, 1
    s_cmp_lg_u32 s86, 0
    s_cbranch_scc1 NON_3
NOND_4:
    v_readfirstlane_b32 s98, v26
    v_readfirstlane_b32 s99, v27
    s_barrier
    s_cmp_lg_u32 s64, 0
    s_cbranch_scc1 PUB_5
    s_mov_b64 exec, 1
    v_mov_b32 v26, s98
    v_mov_b32 v27, s99
    s_lshl_b32 s86, s2, 7
    s_add_u32 s86, s86, 14680064
    buffer_store_dwordx2 v[26:27], off, s[48:51], s86 sc1
    s_mov_b64 exec, -1
PUB_5:
    s_add_u32 m0, s23, 86016
    s_add_u32 s18, s19, 3
    s_and_b32 s18, s18, 7
    s_lshl_b32 s22, s18, 7
    s_add_u32 s22, s22, s80
    buffer_load_dwordx4 v2, s[36:39], s22 offen lds
    s_cmp_eq_u32 s64, 1
    s_cbranch_scc1 EX1_6
    s_cmp_ge_u32 s64, 2
    s_cbranch_scc1 EX2_7
    v_lshl_add_u32 v109, v105, 4, v104
    v_lshl_add_u32 v110, v105, 3, v104
    v_lshl_add_u32 v111, v106, 3, v107
    s_mov_b32 s92, 0x07060100
    ds_read_b128 v[128:131], v109 offset:0
    ds_read_b64 v[132:133], v110 offset:16
    ds_read_u16 v134, v111 offset:16
    ds_read_b128 v[144:147], v109 offset:1536
    ds_read_b64 v[148:149], v110 offset:1552
    ds_read_u16 v150, v111 offset:1552
    buffer_load_dwordx4 v3, s[36:39], s22 offen offset:1024 lds
    buffer_load_dwordx4 v30, s[36:39], s22 offen offset:2048 lds
    buffer_load_dwordx4 v25, s[36:39], s22 offen offset:3072 lds
    s_add_u32 m0, s3, 102400
    s_mul_i32 s21, s18, 176128
    s_add_u32 s21, s21, s81
    buffer_load_dwordx4 v4, s[40:43], s21 offen lds
    buffer_load_dwordx4 v5, s[40:43], s21 offen offset:1024 lds
    buffer_load_dwordx4 v6, s[40:43], s21 offen offset:2048 lds
    s_waitcnt lgkmcnt(0)
    s_mov_b32 exec_lo, -1
    s_mov_b32 exec_hi, 0
    v_alignbit_b32 v136, v131, v131, 16
    v_alignbit_b32 v137, v130, v130, 16
    v_alignbit_b32 v138, v129, v129, 16
    v_alignbit_b32 v139, v128, v128, 16
    s_mov_b32 exec_lo, 0
    s_mov_b32 exec_hi, -1
    v_perm_b32 v136, v133, v134, s92
    s_mov_b32 s93, 0x05040504
    v_perm_b32 v137, v133, v133, s93
    s_mov_b32 s94, 0x07060100
    v_perm_b32 v138, v132, v133, s94
    v_perm_b32 v139, v132, v132, s93
    s_mov_b64 exec, -1
    ds_write_b128 v108, v[136:139] offset:0
    s_mov_b32 exec_lo, -1
    s_mov_b32 exec_hi, 0
    v_alignbit_b32 v152, v147, v147, 16
    v_alignbit_b32 v153, v146, v146, 16
    v_alignbit_b32 v154, v145, v145, 16
    v_alignbit_b32 v155, v144, v144, 16
    s_mov_b32 exec_lo, 0
    s_mov_b32 exec_hi, -1
    v_perm_b32 v152, v149, v150, s92
    s_mov_b32 s93, 0x05040504
    v_perm_b32 v153, v149, v149, s93
    s_mov_b32 s94, 0x07060100
    v_perm_b32 v154, v148, v149, s94
    v_perm_b32 v155, v148, v148, s93
    s_mov_b64 exec, -1
    ds_write_b128 v108, v[152:155] offset:4336
    s_waitcnt lgkmcnt(0)
    s_branch EXD_8
EX1_6:
    v_lshl_add_u32 v109, v105, 2, v104
    v_lshl_add_u32 v111, v106, 2, v107
    s_mov_b32 s92, 0x01000100
    s_mov_b32 s93, 0x03020302
    s_mov_b32 s94, 0x01000302
    ds_read_b32 v128, v109 offset:32
    ds_read_u16 v129, v111 offset:32
    ds_read_b32 v144, v109 offset:1568
    ds_read_u16 v145, v111 offset:1568
    buffer_load_dwordx4 v3, s[36:39], s22 offen offset:1024 lds
    buffer_load_dwordx4 v30, s[36:39], s22 offen offset:2048 lds
    buffer_load_dwordx4 v25, s[36:39], s22 offen offset:3072 lds
    s_add_u32 m0, s3, 102400
    s_mul_i32 s21, s18, 176128
    s_add_u32 s21, s21, s81
    buffer_load_dwordx4 v4, s[40:43], s21 offen lds
    buffer_load_dwordx4 v5, s[40:43], s21 offen offset:1024 lds
    buffer_load_dwordx4 v6, s[40:43], s21 offen offset:2048 lds
    s_waitcnt lgkmcnt(0)
    v_perm_b32 v136, v129, v129, s92
    v_perm_b32 v137, v128, v128, s93
    v_perm_b32 v138, v128, v128, s94
    v_perm_b32 v139, v128, v128, s92
    ds_write_b128 v108, v[136:139] offset:0
    v_perm_b32 v152, v145, v145, s92
    v_perm_b32 v153, v144, v144, s93
    v_perm_b32 v154, v144, v144, s94
    v_perm_b32 v155, v144, v144, s92
    ds_write_b128 v108, v[152:155] offset:4336
    s_waitcnt lgkmcnt(0)
    s_branch EXD_8
EX2_7:
    v_lshl_add_u32 v109, v105, 1, v104
    v_lshl_add_u32 v111, v106, 1, v107
    s_mov_b32 s92, 0x01000100
    s_mov_b32 s93, 0x05040100
    v_and_b32 v110, 1, v0
    v_cmp_eq_u32 vcc, 0, v110
    ds_read_u16 v128, v109 offset:48
    ds_read_u16 v129, v111 offset:48
    ds_read_u16 v144, v109 offset:1584
    ds_read_u16 v145, v111 offset:1584
    buffer_load_dwordx4 v3, s[36:39], s22 offen offset:1024 lds
    buffer_load_dwordx4 v30, s[36:39], s22 offen offset:2048 lds
    buffer_load_dwordx4 v25, s[36:39], s22 offen offset:3072 lds
    s_add_u32 m0, s3, 102400
    s_mul_i32 s21, s18, 176128
    s_add_u32 s21, s21, s81
    buffer_load_dwordx4 v4, s[40:43], s21 offen lds
    buffer_load_dwordx4 v5, s[40:43], s21 offen offset:1024 lds
    buffer_load_dwordx4 v6, s[40:43], s21 offen offset:2048 lds
    s_waitcnt lgkmcnt(0)
    v_cndmask_b32 v130, v129, v128, vcc
    v_perm_b32 v136, v129, v129, s92
    v_perm_b32 v137, v130, v129, s93
    v_perm_b32 v138, v128, v128, s92
    v_mov_b32 v139, v138
    ds_write_b128 v108, v[136:139] offset:0
    v_cndmask_b32 v146, v145, v144, vcc
    v_perm_b32 v152, v145, v145, s92
    v_perm_b32 v153, v146, v145, s93
    v_perm_b32 v154, v144, v144, s92
    v_mov_b32 v155, v154
    ds_write_b128 v108, v[152:155] offset:4336
    v_lshlrev_b32 v110, 4, v1
    v_add_u32 v110, 152064, v110
    v_mov_b32 v128, 0
    v_mov_b32 v129, 0
    v_mov_b32 v130, 0
    v_mov_b32 v131, 0
    s_mov_b64 exec, 0x7fff
    ds_write_b128 v110, v[128:131] offset:0
    ds_write_b128 v110, v[128:131] offset:4336
    s_mov_b64 exec, -1
    s_waitcnt lgkmcnt(0)
EXD_8:
    s_cmp_eq_u32 s68, 15
    s_cbranch_scc1 GATE_9
    v_add_u32 v144, 86016, v7
    v_add_u32 v145, 86016, v8
    v_add_u32 v146, 53248, v9
    v_add_u32 v147, 53248, v10
    ds_read_b128 v[80:83], v7 offset:0
    ds_read_b128 v[84:87], v7 offset:2048
    ds_read_b64_tr_b16 v[88:89], v9 offset:0
    ds_read_b64_tr_b16 v[90:91], v9 offset:768
    ds_read_b64_tr_b16 v[92:93], v10 offset:32
    ds_read_b64_tr_b16 v[94:95], v10 offset:800
    ds_read_b64_tr_b16 v[96:97], v9 offset:64
    ds_read_b64_tr_b16 v[98:99], v9 offset:832
    ds_read_b64_tr_b16 v[100:101], v10 offset:96
    ds_read_b64_tr_b16 v[102:103], v10 offset:864
    ds_read_b64_tr_b16 v[104:105], v9 offset:128
    ds_read_b64_tr_b16 v[106:107], v9 offset:896
    ds_read_b64_tr_b16 v[108:109], v10 offset:160
    ds_read_b64_tr_b16 v[110:111], v10 offset:928
    s_waitcnt lgkmcnt(10)
    v_mfma_f32_16x16x32_bf16 v[32:35], v[88:91], v[80:83], 0
    ds_read_b128 v[112:115], v8 offset:0
    ds_read_b128 v[116:119], v8 offset:2048
    v_mfma_f32_16x16x32_bf16 v[36:39], v[88:91], v[84:87], 0
    s_add_u32 m0, s23, 114688
    s_add_u32 s18, s19, 4
    s_and_b32 s18, s18, 7
    s_lshl_b32 s22, s18, 7
    s_add_u32 s22, s22, s80
    s_waitcnt lgkmcnt(10)
    v_mfma_f32_16x16x32_bf16 v[40:43], v[92:95], v[80:83], 0
    buffer_load_dwordx4 v2, s[36:39], s22 offen lds
    ds_read_b64_tr_b16 v[120:121], v9 offset:6144
    v_mfma_f32_16x16x32_bf16 v[44:47], v[92:95], v[84:87], 0
    ds_read_b64_tr_b16 v[122:123], v9 offset:6912
    ds_read_b64_tr_b16 v[124:125], v10 offset:6176
    s_waitcnt lgkmcnt(11)
    v_mfma_f32_16x16x32_bf16 v[48:51], v[96:99], v[80:83], 0
    ds_read_b64_tr_b16 v[126:127], v10 offset:6944
    ds_read_b64_tr_b16 v[128:129], v9 offset:6208
    v_mfma_f32_16x16x32_bf16 v[52:55], v[96:99], v[84:87], 0
    ds_read_b64_tr_b16 v[130:131], v9 offset:6976
    ds_read_b64_tr_b16 v[132:133], v10 offset:6240
    s_waitcnt lgkmcnt(13)
    v_mfma_f32_16x16x32_bf16 v[56:59], v[100:103], v[80:83], 0
    buffer_load_dwordx4 v3, s[36:39], s22 offen offset:1024 lds
    ds_read_b64_tr_b16 v[134:135], v10 offset:7008
    v_mfma_f32_16x16x32_bf16 v[60:63], v[100:103], v[84:87], 0
    ds_read_b64_tr_b16 v[136:137], v9 offset:6272
    ds_read_b64_tr_b16 v[138:139], v9 offset:7040
    s_waitcnt lgkmcnt(14)
    v_mfma_f32_16x16x32_bf16 v[64:67], v[104:107], v[80:83], 0
    ds_read_b64_tr_b16 v[140:141], v10 offset:6304
    ds_read_b64_tr_b16 v[142:143], v10 offset:7072
    v_mfma_f32_16x16x32_bf16 v[68:71], v[104:107], v[84:87], 0
    s_waitcnt lgkmcnt(14)
    v_mfma_f32_16x16x32_bf16 v[72:75], v[108:111], v[80:83], 0
    buffer_load_dwordx4 v30, s[36:39], s22 offen offset:2048 lds
    v_mfma_f32_16x16x32_bf16 v[76:79], v[108:111], v[84:87], 0
    s_waitcnt lgkmcnt(0)
    s_barrier
    s_cmp_lg_u32 s64, 0
    s_cbranch_scc1 ZA_11
    v_lshlrev_b32 v26, 3, v1
    v_add_u32 v26, 160768, v26
    v_mov_b32 v214, 0
    v_mov_b32 v215, 0
    ds_write_b64 v26, v[214:215]
    s_waitcnt lgkmcnt(0)
ZA_11:
    v_mfma_f32_16x16x32_bf16 v[32:35], v[120:123], v[112:115], v[32:35]
    ds_read_b128 v[80:83], v7 offset:16384
    ds_read_b128 v[84:87], v7 offset:18432
    v_mfma_f32_16x16x32_bf16 v[36:39], v[120:123], v[116:119], v[36:39]
    buffer_load_dwordx4 v25, s[36:39], s22 offen offset:3072 lds
    ds_read_b64_tr_b16 v[88:89], v9 offset:12288
    v_mfma_f32_16x16x32_bf16 v[40:43], v[124:127], v[112:115], v[40:43]
    ds_read_b64_tr_b16 v[90:91], v9 offset:13056
    ds_read_b64_tr_b16 v[92:93], v10 offset:12320
    v_mfma_f32_16x16x32_bf16 v[44:47], v[124:127], v[116:119], v[44:47]
    s_add_u32 m0, s3, 131072
    s_mul_i32 s21, s18, 176128
    s_add_u32 s21, s21, s81
    v_mfma_f32_16x16x32_bf16 v[48:51], v[128:131], v[112:115], v[48:51]
    buffer_load_dwordx4 v4, s[40:43], s21 offen lds
    ds_read_b64_tr_b16 v[94:95], v10 offset:13088
    v_mfma_f32_16x16x32_bf16 v[52:55], v[128:131], v[116:119], v[52:55]
    ds_read_b64_tr_b16 v[96:97], v9 offset:12352
    ds_read_b64_tr_b16 v[98:99], v9 offset:13120
    v_mfma_f32_16x16x32_bf16 v[56:59], v[132:135], v[112:115], v[56:59]
    ds_read_b64_tr_b16 v[100:101], v10 offset:12384
    ds_read_b64_tr_b16 v[102:103], v10 offset:13152
    v_mfma_f32_16x16x32_bf16 v[60:63], v[132:135], v[116:119], v[60:63]
    buffer_load_dwordx4 v5, s[40:43], s21 offen offset:1024 lds
    ds_read_b64_tr_b16 v[104:105], v9 offset:12416
    v_mfma_f32_16x16x32_bf16 v[64:67], v[136:139], v[112:115], v[64:67]
    ds_read_b64_tr_b16 v[106:107], v9 offset:13184
    ds_read_b64_tr_b16 v[108:109], v10 offset:12448
    v_mfma_f32_16x16x32_bf16 v[68:71], v[136:139], v[116:119], v[68:71]
    ds_read_b64_tr_b16 v[110:111], v10 offset:13216
    v_mfma_f32_16x16x32_bf16 v[72:75], v[140:143], v[112:115], v[72:75]
    buffer_load_dwordx4 v6, s[40:43], s21 offen offset:2048 lds
    v_mfma_f32_16x16x32_bf16 v[76:79], v[140:143], v[116:119], v[76:79]
    s_waitcnt lgkmcnt(10)
    v_mfma_f32_16x16x32_bf16 v[32:35], v[88:91], v[80:83], v[32:35]
    ds_read_b128 v[112:115], v8 offset:16384
    ds_read_b128 v[116:119], v8 offset:18432
    v_mfma_f32_16x16x32_bf16 v[36:39], v[88:91], v[84:87], v[36:39]
    s_add_u32 m0, s23, 0
    s_add_u32 s18, s19, 5
    s_and_b32 s18, s18, 7
    s_lshl_b32 s22, s18, 7
    s_add_u32 s22, s22, s80
    s_waitcnt lgkmcnt(10)
    v_mfma_f32_16x16x32_bf16 v[40:43], v[92:95], v[80:83], v[40:43]
    buffer_load_dwordx4 v2, s[36:39], s22 offen lds
    ds_read_b64_tr_b16 v[120:121], v9 offset:18432
    v_mfma_f32_16x16x32_bf16 v[44:47], v[92:95], v[84:87], v[44:47]
    ds_read_b64_tr_b16 v[122:123], v9 offset:19200
    ds_read_b64_tr_b16 v[124:125], v10 offset:18464
    s_waitcnt lgkmcnt(11)
    v_mfma_f32_16x16x32_bf16 v[48:51], v[96:99], v[80:83], v[48:51]
    ds_read_b64_tr_b16 v[126:127], v10 offset:19232
    ds_read_b64_tr_b16 v[128:129], v9 offset:18496
    v_mfma_f32_16x16x32_bf16 v[52:55], v[96:99], v[84:87], v[52:55]
    ds_read_b64_tr_b16 v[130:131], v9 offset:19264
    ds_read_b64_tr_b16 v[132:133], v10 offset:18528
    s_waitcnt lgkmcnt(13)
    v_mfma_f32_16x16x32_bf16 v[56:59], v[100:103], v[80:83], v[56:59]
    buffer_load_dwordx4 v3, s[36:39], s22 offen offset:1024 lds
    ds_read_b64_tr_b16 v[134:135], v10 offset:19296
    v_mfma_f32_16x16x32_bf16 v[60:63], v[100:103], v[84:87], v[60:63]
    ds_read_b64_tr_b16 v[136:137], v9 offset:18560
    ds_read_b64_tr_b16 v[138:139], v9 offset:19328
    s_waitcnt lgkmcnt(14)
    v_mfma_f32_16x16x32_bf16 v[64:67], v[104:107], v[80:83], v[64:67]
    ds_read_b64_tr_b16 v[140:141], v10 offset:18592
    ds_read_b64_tr_b16 v[142:143], v10 offset:19360
    v_mfma_f32_16x16x32_bf16 v[68:71], v[104:107], v[84:87], v[68:71]
    s_waitcnt lgkmcnt(14)
    v_mfma_f32_16x16x32_bf16 v[72:75], v[108:111], v[80:83], v[72:75]
    buffer_load_dwordx4 v30, s[36:39], s22 offen offset:2048 lds
    v_mfma_f32_16x16x32_bf16 v[76:79], v[108:111], v[84:87], v[76:79]
    s_waitcnt lgkmcnt(0)
    s_waitcnt vmcnt(19)
    s_barrier
    v_mfma_f32_16x16x32_bf16 v[32:35], v[120:123], v[112:115], v[32:35]
    ds_read_b128 v[80:83], v7 offset:32768
    ds_read_b128 v[84:87], v7 offset:34816
    v_mfma_f32_16x16x32_bf16 v[36:39], v[120:123], v[116:119], v[36:39]
    buffer_load_dwordx4 v25, s[36:39], s22 offen offset:3072 lds
    ds_read_b64_tr_b16 v[88:89], v9 offset:24576
    v_mfma_f32_16x16x32_bf16 v[40:43], v[124:127], v[112:115], v[40:43]
    ds_read_b64_tr_b16 v[90:91], v9 offset:25344
    ds_read_b64_tr_b16 v[92:93], v10 offset:24608
    v_mfma_f32_16x16x32_bf16 v[44:47], v[124:127], v[116:119], v[44:47]
    s_add_u32 m0, s3, 49152
    s_mul_i32 s21, s18, 176128
    s_add_u32 s21, s21, s81
    v_mfma_f32_16x16x32_bf16 v[48:51], v[128:131], v[112:115], v[48:51]
    buffer_load_dwordx4 v4, s[40:43], s21 offen lds
    ds_read_b64_tr_b16 v[94:95], v10 offset:25376
    v_mfma_f32_16x16x32_bf16 v[52:55], v[128:131], v[116:119], v[52:55]
    ds_read_b64_tr_b16 v[96:97], v9 offset:24640
    ds_read_b64_tr_b16 v[98:99], v9 offset:25408
    v_mfma_f32_16x16x32_bf16 v[56:59], v[132:135], v[112:115], v[56:59]
    ds_read_b64_tr_b16 v[100:101], v10 offset:24672
    ds_read_b64_tr_b16 v[102:103], v10 offset:25440
    v_mfma_f32_16x16x32_bf16 v[60:63], v[132:135], v[116:119], v[60:63]
    buffer_load_dwordx4 v5, s[40:43], s21 offen offset:1024 lds
    ds_read_b64_tr_b16 v[104:105], v9 offset:24704
    v_mfma_f32_16x16x32_bf16 v[64:67], v[136:139], v[112:115], v[64:67]
    ds_read_b64_tr_b16 v[106:107], v9 offset:25472
    ds_read_b64_tr_b16 v[108:109], v10 offset:24736
    v_mfma_f32_16x16x32_bf16 v[68:71], v[136:139], v[116:119], v[68:71]
    ds_read_b64_tr_b16 v[110:111], v10 offset:25504
    v_mfma_f32_16x16x32_bf16 v[72:75], v[140:143], v[112:115], v[72:75]
    buffer_load_dwordx4 v6, s[40:43], s21 offen offset:2048 lds
    v_mfma_f32_16x16x32_bf16 v[76:79], v[140:143], v[116:119], v[76:79]
    s_waitcnt lgkmcnt(10)
    v_mfma_f32_16x16x32_bf16 v[32:35], v[88:91], v[80:83], v[32:35]
    ds_read_b128 v[112:115], v8 offset:32768
    ds_read_b128 v[116:119], v8 offset:34816
    v_mfma_f32_16x16x32_bf16 v[36:39], v[88:91], v[84:87], v[36:39]
    s_add_u32 m0, s23, 16384
    s_add_u32 s18, s19, 6
    s_and_b32 s18, s18, 7
    s_lshl_b32 s22, s18, 7
    s_add_u32 s22, s22, s80
    s_waitcnt lgkmcnt(10)
    v_mfma_f32_16x16x32_bf16 v[40:43], v[92:95], v[80:83], v[40:43]
    buffer_load_dwordx4 v2, s[36:39], s22 offen lds
    ds_read_b64_tr_b16 v[120:121], v9 offset:30720
    v_mfma_f32_16x16x32_bf16 v[44:47], v[92:95], v[84:87], v[44:47]
    ds_read_b64_tr_b16 v[122:123], v9 offset:31488
    ds_read_b64_tr_b16 v[124:125], v10 offset:30752
    s_waitcnt lgkmcnt(11)
    v_mfma_f32_16x16x32_bf16 v[48:51], v[96:99], v[80:83], v[48:51]
    ds_read_b64_tr_b16 v[126:127], v10 offset:31520
    ds_read_b64_tr_b16 v[128:129], v9 offset:30784
    v_mfma_f32_16x16x32_bf16 v[52:55], v[96:99], v[84:87], v[52:55]
    ds_read_b64_tr_b16 v[130:131], v9 offset:31552
    ds_read_b64_tr_b16 v[132:133], v10 offset:30816
    s_waitcnt lgkmcnt(13)
    v_mfma_f32_16x16x32_bf16 v[56:59], v[100:103], v[80:83], v[56:59]
    buffer_load_dwordx4 v3, s[36:39], s22 offen offset:1024 lds
    ds_read_b64_tr_b16 v[134:135], v10 offset:31584
    v_mfma_f32_16x16x32_bf16 v[60:63], v[100:103], v[84:87], v[60:63]
    ds_read_b64_tr_b16 v[136:137], v9 offset:30848
    ds_read_b64_tr_b16 v[138:139], v9 offset:31616
    s_waitcnt lgkmcnt(14)
    v_mfma_f32_16x16x32_bf16 v[64:67], v[104:107], v[80:83], v[64:67]
    ds_read_b64_tr_b16 v[140:141], v10 offset:30880
    ds_read_b64_tr_b16 v[142:143], v10 offset:31648
    v_mfma_f32_16x16x32_bf16 v[68:71], v[104:107], v[84:87], v[68:71]
    s_waitcnt lgkmcnt(14)
    v_mfma_f32_16x16x32_bf16 v[72:75], v[108:111], v[80:83], v[72:75]
    buffer_load_dwordx4 v30, s[36:39], s22 offen offset:2048 lds
    v_mfma_f32_16x16x32_bf16 v[76:79], v[108:111], v[84:87], v[76:79]
    s_waitcnt lgkmcnt(0)
    s_waitcnt vmcnt(17)
    s_barrier
    buffer_load_dwordx2 v[26:27], v11, s[48:51], 0 offen sc1
    v_mfma_f32_16x16x32_bf16 v[32:35], v[120:123], v[112:115], v[32:35]
    ds_read_b128 v[80:83], v144 offset:0
    ds_read_b128 v[84:87], v144 offset:2048
    v_mfma_f32_16x16x32_bf16 v[36:39], v[120:123], v[116:119], v[36:39]
    buffer_load_dwordx4 v25, s[36:39], s22 offen offset:3072 lds
    ds_read_b64_tr_b16 v[88:89], v146 offset:0
    v_mfma_f32_16x16x32_bf16 v[40:43], v[124:127], v[112:115], v[40:43]
    ds_read_b64_tr_b16 v[90:91], v146 offset:768
    ds_read_b64_tr_b16 v[92:93], v147 offset:32
    v_mfma_f32_16x16x32_bf16 v[44:47], v[124:127], v[116:119], v[44:47]
    s_add_u32 m0, s3, 61440
    s_mul_i32 s21, s18, 176128
    s_add_u32 s21, s21, s81
    v_mfma_f32_16x16x32_bf16 v[48:51], v[128:131], v[112:115], v[48:51]
    buffer_load_dwordx4 v4, s[40:43], s21 offen lds
    ds_read_b64_tr_b16 v[94:95], v147 offset:800
    v_mfma_f32_16x16x32_bf16 v[52:55], v[128:131], v[116:119], v[52:55]
    ds_read_b64_tr_b16 v[96:97], v146 offset:64
    ds_read_b64_tr_b16 v[98:99], v146 offset:832
    v_mfma_f32_16x16x32_bf16 v[56:59], v[132:135], v[112:115], v[56:59]
    ds_read_b64_tr_b16 v[100:101], v147 offset:96
    ds_read_b64_tr_b16 v[102:103], v147 offset:864
    v_mfma_f32_16x16x32_bf16 v[60:63], v[132:135], v[116:119], v[60:63]
    buffer_load_dwordx4 v5, s[40:43], s21 offen offset:1024 lds
    ds_read_b64_tr_b16 v[104:105], v146 offset:128
    v_mfma_f32_16x16x32_bf16 v[64:67], v[136:139], v[112:115], v[64:67]
    ds_read_b64_tr_b16 v[106:107], v146 offset:896
    ds_read_b64_tr_b16 v[108:109], v147 offset:160
    v_mfma_f32_16x16x32_bf16 v[68:71], v[136:139], v[116:119], v[68:71]
    ds_read_b64_tr_b16 v[110:111], v147 offset:928
    v_mfma_f32_16x16x32_bf16 v[72:75], v[140:143], v[112:115], v[72:75]
    buffer_load_dwordx4 v6, s[40:43], s21 offen offset:2048 lds
    v_mfma_f32_16x16x32_bf16 v[76:79], v[140:143], v[116:119], v[76:79]
    s_waitcnt lgkmcnt(10)
    v_mfma_f32_16x16x32_bf16 v[32:35], v[88:91], v[80:83], v[32:35]
    ds_read_b128 v[112:115], v145 offset:0
    ds_read_b128 v[116:119], v145 offset:2048
    v_mfma_f32_16x16x32_bf16 v[36:39], v[88:91], v[84:87], v[36:39]
    s_add_u32 m0, s23, 32768
    s_add_u32 s18, s19, 7
    s_and_b32 s18, s18, 7
    s_lshl_b32 s22, s18, 7
    s_add_u32 s22, s22, s80
    s_waitcnt lgkmcnt(10)
    v_mfma_f32_16x16x32_bf16 v[40:43], v[92:95], v[80:83], v[40:43]
    buffer_load_dwordx4 v2, s[36:39], s22 offen lds
    ds_read_b64_tr_b16 v[120:121], v146 offset:6144
    v_mfma_f32_16x16x32_bf16 v[44:47], v[92:95], v[84:87], v[44:47]
    ds_read_b64_tr_b16 v[122:123], v146 offset:6912
    ds_read_b64_tr_b16 v[124:125], v147 offset:6176
    s_waitcnt lgkmcnt(11)
    v_mfma_f32_16x16x32_bf16 v[48:51], v[96:99], v[80:83], v[48:51]
    ds_read_b64_tr_b16 v[126:127], v147 offset:6944
    ds_read_b64_tr_b16 v[128:129], v146 offset:6208
    v_mfma_f32_16x16x32_bf16 v[52:55], v[96:99], v[84:87], v[52:55]
    ds_read_b64_tr_b16 v[130:131], v146 offset:6976
    ds_read_b64_tr_b16 v[132:133], v147 offset:6240
    s_waitcnt lgkmcnt(13)
    v_mfma_f32_16x16x32_bf16 v[56:59], v[100:103], v[80:83], v[56:59]
    buffer_load_dwordx4 v3, s[36:39], s22 offen offset:1024 lds
    ds_read_b64_tr_b16 v[134:135], v147 offset:7008
    v_mfma_f32_16x16x32_bf16 v[60:63], v[100:103], v[84:87], v[60:63]
    ds_read_b64_tr_b16 v[136:137], v146 offset:6272
    ds_read_b64_tr_b16 v[138:139], v146 offset:7040
    s_waitcnt lgkmcnt(14)
    v_mfma_f32_16x16x32_bf16 v[64:67], v[104:107], v[80:83], v[64:67]
    ds_read_b64_tr_b16 v[140:141], v147 offset:6304
    ds_read_b64_tr_b16 v[142:143], v147 offset:7072
    v_mfma_f32_16x16x32_bf16 v[68:71], v[104:107], v[84:87], v[68:71]
    s_waitcnt lgkmcnt(14)
    v_mfma_f32_16x16x32_bf16 v[72:75], v[108:111], v[80:83], v[72:75]
    buffer_load_dwordx4 v30, s[36:39], s22 offen offset:2048 lds
    v_mfma_f32_16x16x32_bf16 v[76:79], v[108:111], v[84:87], v[76:79]
    s_waitcnt lgkmcnt(0)
    s_waitcnt vmcnt(18)
    s_barrier
    v_mfma_f32_16x16x32_bf16 v[32:35], v[120:123], v[112:115], v[32:35]
    ds_read_b128 v[80:83], v144 offset:28672
    ds_read_b128 v[84:87], v144 offset:30720
    v_mfma_f32_16x16x32_bf16 v[36:39], v[120:123], v[116:119], v[36:39]
    buffer_load_dwordx4 v25, s[36:39], s22 offen offset:3072 lds
    ds_read_b64_tr_b16 v[88:89], v146 offset:28672
    v_mfma_f32_16x16x32_bf16 v[40:43], v[124:127], v[112:115], v[40:43]
    ds_read_b64_tr_b16 v[90:91], v146 offset:29440
    ds_read_b64_tr_b16 v[92:93], v147 offset:28704
    v_mfma_f32_16x16x32_bf16 v[44:47], v[124:127], v[116:119], v[44:47]
    s_add_u32 m0, s3, 73728
    s_mul_i32 s21, s18, 176128
    s_add_u32 s21, s21, s81
    v_mfma_f32_16x16x32_bf16 v[48:51], v[128:131], v[112:115], v[48:51]
    buffer_load_dwordx4 v4, s[40:43], s21 offen lds
    ds_read_b64_tr_b16 v[94:95], v147 offset:29472
    v_mfma_f32_16x16x32_bf16 v[52:55], v[128:131], v[116:119], v[52:55]
    ds_read_b64_tr_b16 v[96:97], v146 offset:28736
    ds_read_b64_tr_b16 v[98:99], v146 offset:29504
    v_mfma_f32_16x16x32_bf16 v[56:59], v[132:135], v[112:115], v[56:59]
    ds_read_b64_tr_b16 v[100:101], v147 offset:28768
    ds_read_b64_tr_b16 v[102:103], v147 offset:29536
    v_mfma_f32_16x16x32_bf16 v[60:63], v[132:135], v[116:119], v[60:63]
    buffer_load_dwordx4 v5, s[40:43], s21 offen offset:1024 lds
    ds_read_b64_tr_b16 v[104:105], v146 offset:28800
    v_mfma_f32_16x16x32_bf16 v[64:67], v[136:139], v[112:115], v[64:67]
    ds_read_b64_tr_b16 v[106:107], v146 offset:29568
    ds_read_b64_tr_b16 v[108:109], v147 offset:28832
    v_mfma_f32_16x16x32_bf16 v[68:71], v[136:139], v[116:119], v[68:71]
    ds_read_b64_tr_b16 v[110:111], v147 offset:29600
    v_mfma_f32_16x16x32_bf16 v[72:75], v[140:143], v[112:115], v[72:75]
    buffer_load_dwordx4 v6, s[40:43], s21 offen offset:2048 lds
    v_mfma_f32_16x16x32_bf16 v[76:79], v[140:143], v[116:119], v[76:79]
    s_waitcnt lgkmcnt(10)
    v_mfma_f32_16x16x32_bf16 v[32:35], v[88:91], v[80:83], v[32:35]
    ds_read_b128 v[112:115], v145 offset:28672
    ds_read_b128 v[116:119], v145 offset:30720
    v_mfma_f32_16x16x32_bf16 v[36:39], v[88:91], v[84:87], v[36:39]
    ds_read_b64_tr_b16 v[120:121], v146 offset:34816
    ds_read_b64_tr_b16 v[122:123], v146 offset:35584
    s_waitcnt lgkmcnt(12)
    v_mfma_f32_16x16x32_bf16 v[40:43], v[92:95], v[80:83], v[40:43]
    ds_read_b64_tr_b16 v[124:125], v147 offset:34848
    ds_read_b64_tr_b16 v[126:127], v147 offset:35616
    v_mfma_f32_16x16x32_bf16 v[44:47], v[92:95], v[84:87], v[44:47]
    ds_read_b64_tr_b16 v[128:129], v146 offset:34880
    ds_read_b64_tr_b16 v[130:131], v146 offset:35648
    s_waitcnt lgkmcnt(14)
    v_mfma_f32_16x16x32_bf16 v[48:51], v[96:99], v[80:83], v[48:51]
    ds_read_b64_tr_b16 v[132:133], v147 offset:34912
    ds_read_b64_tr_b16 v[134:135], v147 offset:35680
    v_mfma_f32_16x16x32_bf16 v[52:55], v[96:99], v[84:87], v[52:55]
    ds_read_b64_tr_b16 v[136:137], v146 offset:34944
    ds_read_b64_tr_b16 v[138:139], v146 offset:35712
    s_waitcnt lgkmcnt(15)
    v_mfma_f32_16x16x32_bf16 v[56:59], v[100:103], v[80:83], v[56:59]
    ds_read_b64_tr_b16 v[140:141], v147 offset:34976
    ds_read_b64_tr_b16 v[142:143], v147 offset:35744
    v_mfma_f32_16x16x32_bf16 v[60:63], v[100:103], v[84:87], v[60:63]
    s_waitcnt lgkmcnt(15)
    v_mfma_f32_16x16x32_bf16 v[64:67], v[104:107], v[80:83], v[64:67]
    v_mfma_f32_16x16x32_bf16 v[68:71], v[104:107], v[84:87], v[68:71]
    s_waitcnt lgkmcnt(14)
    v_mfma_f32_16x16x32_bf16 v[72:75], v[108:111], v[80:83], v[72:75]
    v_mfma_f32_16x16x32_bf16 v[76:79], v[108:111], v[84:87], v[76:79]
    s_waitcnt vmcnt(11)
    v_cmp_ne_u64 vcc, s[98:99], v[26:27]
    s_cbranch_vccz POLLD_13
    s_mov_b32 s86, 4000
POLL_12:
    s_sleep 2
    buffer_load_dwordx2 v[26:27], v11, s[48:51], 0 offen sc1
    s_waitcnt vmcnt(0)
    v_cmp_ne_u64 vcc, s[98:99], v[26:27]
    s_cbranch_vccz POLLD_13
    s_sub_u32 s86, s86, 1
    s_cmp_lg_u32 s86, 0
    s_cbranch_scc1 POLL_12
POLLD_13:
    s_lshr_b32 s74, s64, 1
    s_and_b32 s75, s64, 1
    s_add_u32 s76, s74, s71
    s_mul_i32 s76, s76, 4224
    s_add_u32 s76, s76, 128
    s_mul_i32 s77, s74, 33024
    s_mul_i32 s75, s75, 16512
    s_add_u32 s77, s77, s75
    s_add_u32 s77, s77, 86016
    s_and_b32 s75, s64, 1
    s_lshl_b32 s75, s75, 3
    s_add_u32 s76, s76, s75
    s_waitcnt lgkmcnt(0)
    s_barrier
    v_mfma_f32_16x16x32_bf16 v[32:35], v[120:123], v[112:115], v[32:35]
    ds_read_b128 v[80:83], v7 offset:0
    ds_read_b128 v[84:87], v7 offset:2048
    v_mfma_f32_16x16x32_bf16 v[36:39], v[120:123], v[116:119], v[36:39]
    s_add_u32 m0, s77, 0
    s_add_u32 s22, s76, 2228212
    v_mfma_f32_16x16x32_bf16 v[40:43], v[124:127], v[112:115], v[40:43]
    buffer_load_dwordx4 v14, s[48:51], s22 offen sc1 lds
    ds_read_b64_tr_b16 v[88:89], v9 offset:0
    v_mfma_f32_16x16x32_bf16 v[44:47], v[124:127], v[116:119], v[44:47]
    ds_read_b64_tr_b16 v[90:91], v9 offset:768
    ds_read_b64_tr_b16 v[92:93], v10 offset:32
    v_mfma_f32_16x16x32_bf16 v[48:51], v[128:131], v[112:115], v[48:51]
    ds_read_b64_tr_b16 v[94:95], v10 offset:800
    ds_read_b64_tr_b16 v[96:97], v9 offset:64
    v_mfma_f32_16x16x32_bf16 v[52:55], v[128:131], v[116:119], v[52:55]
    ds_read_b64_tr_b16 v[98:99], v9 offset:832
    ds_read_b64_tr_b16 v[100:101], v10 offset:96
    v_mfma_f32_16x16x32_bf16 v[56:59], v[132:135], v[112:115], v[56:59]
    buffer_load_dwordx4 v14, s[48:51], s22 offen offset:1024 sc1 lds
    ds_read_b64_tr_b16 v[102:103], v10 offset:864
    v_mfma_f32_16x16x32_bf16 v[60:63], v[132:135], v[116:119], v[60:63]
    ds_read_b64_tr_b16 v[104:105], v9 offset:128
    ds_read_b64_tr_b16 v[106:107], v9 offset:896
    v_mfma_f32_16x16x32_bf16 v[64:67], v[136:139], v[112:115], v[64:67]
    ds_read_b64_tr_b16 v[108:109], v10 offset:160
    ds_read_b64_tr_b16 v[110:111], v10 offset:928
    v_mfma_f32_16x16x32_bf16 v[68:71], v[136:139], v[116:119], v[68:71]
    v_mfma_f32_16x16x32_bf16 v[72:75], v[140:143], v[112:115], v[72:75]
    buffer_load_dwordx4 v14, s[48:51], s22 offen offset:2048 sc1 lds
    v_mfma_f32_16x16x32_bf16 v[76:79], v[140:143], v[116:119], v[76:79]
    s_waitcnt lgkmcnt(10)
    v_mfma_f32_16x16x32_bf16 v[32:35], v[88:91], v[80:83], v[32:35]
    ds_read_b128 v[112:115], v8 offset:0
    ds_read_b128 v[116:119], v8 offset:2048
    v_mfma_f32_16x16x32_bf16 v[36:39], v[88:91], v[84:87], v[36:39]
    ds_read_b64_tr_b16 v[120:121], v9 offset:6144
    ds_read_b64_tr_b16 v[122:123], v9 offset:6912
    s_waitcnt lgkmcnt(12)
    v_mfma_f32_16x16x32_bf16 v[40:43], v[92:95], v[80:83], v[40:43]
    ds_read_b64_tr_b16 v[124:125], v10 offset:6176
    ds_read_b64_tr_b16 v[126:127], v10 offset:6944
    v_mfma_f32_16x16x32_bf16 v[44:47], v[92:95], v[84:87], v[44:47]
    buffer_load_dwordx4 v14, s[48:51], s22 offen offset:3072 sc1 lds
    ds_read_b64_tr_b16 v[128:129], v9 offset:6208
    s_waitcnt lgkmcnt(13)
    v_mfma_f32_16x16x32_bf16 v[48:51], v[96:99], v[80:83], v[48:51]
    ds_read_b64_tr_b16 v[130:131], v9 offset:6976
    ds_read_b64_tr_b16 v[132:133], v10 offset:6240
    v_mfma_f32_16x16x32_bf16 v[52:55], v[96:99], v[84:87], v[52:55]
    ds_read_b64_tr_b16 v[134:135], v10 offset:7008
    ds_read_b64_tr_b16 v[136:137], v9 offset:6272
    s_waitcnt lgkmcnt(15)
    v_mfma_f32_16x16x32_bf16 v[56:59], v[100:103], v[80:83], v[56:59]
    ds_read_b64_tr_b16 v[138:139], v9 offset:7040
    ds_read_b64_tr_b16 v[140:141], v10 offset:6304
    v_mfma_f32_16x16x32_bf16 v[60:63], v[100:103], v[84:87], v[60:63]
    ds_read_b64_tr_b16 v[142:143], v10 offset:7072
    s_waitcnt lgkmcnt(15)
    v_mfma_f32_16x16x32_bf16 v[64:67], v[104:107], v[80:83], v[64:67]
    s_add_u32 m0, s77, 4128
    s_sub_u32 s22, s76, 12
    v_mfma_f32_16x16x32_bf16 v[68:71], v[104:107], v[84:87], v[68:71]
    buffer_load_dwordx4 v14, s[48:51], s22 offen sc1 lds
    s_waitcnt lgkmcnt(14)
    v_mfma_f32_16x16x32_bf16 v[72:75], v[108:111], v[80:83], v[72:75]
    v_mfma_f32_16x16x32_bf16 v[76:79], v[108:111], v[84:87], v[76:79]
    s_waitcnt lgkmcnt(0)
    s_waitcnt vmcnt(12)
    s_barrier
    v_mfma_f32_16x16x32_bf16 v[32:35], v[120:123], v[112:115], v[32:35]
    ds_read_b128 v[80:83], v7 offset:16384
    ds_read_b128 v[84:87], v7 offset:18432
    v_mfma_f32_16x16x32_bf16 v[36:39], v[120:123], v[116:119], v[36:39]
    ds_read_b64_tr_b16 v[88:89], v9 offset:12288
    ds_read_b64_tr_b16 v[90:91], v9 offset:13056
    v_mfma_f32_16x16x32_bf16 v[40:43], v[124:127], v[112:115], v[40:43]
    buffer_load_dwordx4 v14, s[48:51], s22 offen offset:1024 sc1 lds
    ds_read_b64_tr_b16 v[92:93], v10 offset:12320
    v_mfma_f32_16x16x32_bf16 v[44:47], v[124:127], v[116:119], v[44:47]
    ds_read_b64_tr_b16 v[94:95], v10 offset:13088
    ds_read_b64_tr_b16 v[96:97], v9 offset:12352
    v_mfma_f32_16x16x32_bf16 v[48:51], v[128:131], v[112:115], v[48:51]
    ds_read_b64_tr_b16 v[98:99], v9 offset:13120
    ds_read_b64_tr_b16 v[100:101], v10 offset:12384
    v_mfma_f32_16x16x32_bf16 v[52:55], v[128:131], v[116:119], v[52:55]
    ds_read_b64_tr_b16 v[102:103], v10 offset:13152
    ds_read_b64_tr_b16 v[104:105], v9 offset:12416
    v_mfma_f32_16x16x32_bf16 v[56:59], v[132:135], v[112:115], v[56:59]
    buffer_load_dwordx4 v14, s[48:51], s22 offen offset:2048 sc1 lds
    ds_read_b64_tr_b16 v[106:107], v9 offset:13184
    v_mfma_f32_16x16x32_bf16 v[60:63], v[132:135], v[116:119], v[60:63]
    ds_read_b64_tr_b16 v[108:109], v10 offset:12448
    ds_read_b64_tr_b16 v[110:111], v10 offset:13216
    v_mfma_f32_16x16x32_bf16 v[64:67], v[136:139], v[112:115], v[64:67]
    v_mfma_f32_16x16x32_bf16 v[68:71], v[136:139], v[116:119], v[68:71]
    v_mfma_f32_16x16x32_bf16 v[72:75], v[140:143], v[112:115], v[72:75]
    buffer_load_dwordx4 v14, s[48:51], s22 offen offset:3072 sc1 lds
    s_add_u32 m0, s77, 8256
    v_mfma_f32_16x16x32_bf16 v[76:79], v[140:143], v[116:119], v[76:79]
    s_waitcnt lgkmcnt(10)
    v_mfma_f32_16x16x32_bf16 v[32:35], v[88:91], v[80:83], v[32:35]
    ds_read_b128 v[112:115], v8 offset:16384
    ds_read_b128 v[116:119], v8 offset:18432
    v_mfma_f32_16x16x32_bf16 v[36:39], v[88:91], v[84:87], v[36:39]
    s_add_u32 s22, s76, 2228216
    ds_read_b64_tr_b16 v[120:121], v9 offset:18432
    s_waitcnt lgkmcnt(11)
    v_mfma_f32_16x16x32_bf16 v[40:43], v[92:95], v[80:83], v[40:43]
    buffer_load_dwordx4 v14, s[48:51], s22 offen sc1 lds
    ds_read_b64_tr_b16 v[122:123], v9 offset:19200
    v_mfma_f32_16x16x32_bf16 v[44:47], v[92:95], v[84:87], v[44:47]
    ds_read_b64_tr_b16 v[124:125], v10 offset:18464
    ds_read_b64_tr_b16 v[126:127], v10 offset:19232
    s_waitcnt lgkmcnt(12)
    v_mfma_f32_16x16x32_bf16 v[48:51], v[96:99], v[80:83], v[48:51]
    ds_read_b64_tr_b16 v[128:129], v9 offset:18496
    ds_read_b64_tr_b16 v[130:131], v9 offset:19264
    v_mfma_f32_16x16x32_bf16 v[52:55], v[96:99], v[84:87], v[52:55]
    ds_read_b64_tr_b16 v[132:133], v10 offset:18528
    ds_read_b64_tr_b16 v[134:135], v10 offset:19296
    s_waitcnt lgkmcnt(14)
    v_mfma_f32_16x16x32_bf16 v[56:59], v[100:103], v[80:83], v[56:59]
    buffer_load_dwordx4 v14, s[48:51], s22 offen offset:1024 sc1 lds
    ds_read_b64_tr_b16 v[136:137], v9 offset:18560
    v_mfma_f32_16x16x32_bf16 v[60:63], v[100:103], v[84:87], v[60:63]
    ds_read_b64_tr_b16 v[138:139], v9 offset:19328
    ds_read_b64_tr_b16 v[140:141], v10 offset:18592
    s_waitcnt lgkmcnt(15)
    v_mfma_f32_16x16x32_bf16 v[64:67], v[104:107], v[80:83], v[64:67]
    ds_read_b64_tr_b16 v[142:143], v10 offset:19360
    v_mfma_f32_16x16x32_bf16 v[68:71], v[104:107], v[84:87], v[68:71]
    s_waitcnt lgkmcnt(14)
    v_mfma_f32_16x16x32_bf16 v[72:75], v[108:111], v[80:83], v[72:75]
    buffer_load_dwordx4 v14, s[48:51], s22 offen offset:2048 sc1 lds
    v_mfma_f32_16x16x32_bf16 v[76:79], v[108:111], v[84:87], v[76:79]
    s_waitcnt lgkmcnt(0)
    s_waitcnt vmcnt(11)
    s_barrier
    v_mfma_f32_16x16x32_bf16 v[32:35], v[120:123], v[112:115], v[32:35]
    ds_read_b128 v[80:83], v7 offset:32768
    ds_read_b128 v[84:87], v7 offset:34816
    v_mfma_f32_16x16x32_bf16 v[36:39], v[120:123], v[116:119], v[36:39]
    ds_read_b64_tr_b16 v[88:89], v9 offset:24576
    ds_read_b64_tr_b16 v[90:91], v9 offset:25344
    v_mfma_f32_16x16x32_bf16 v[40:43], v[124:127], v[112:115], v[40:43]
    ds_read_b64_tr_b16 v[92:93], v10 offset:24608
    ds_read_b64_tr_b16 v[94:95], v10 offset:25376
    v_mfma_f32_16x16x32_bf16 v[44:47], v[124:127], v[116:119], v[44:47]
    buffer_load_dwordx4 v14, s[48:51], s22 offen offset:3072 sc1 lds
    ds_read_b64_tr_b16 v[96:97], v9 offset:24640
    v_mfma_f32_16x16x32_bf16 v[48:51], v[128:131], v[112:115], v[48:51]
    ds_read_b64_tr_b16 v[98:99], v9 offset:25408
    ds_read_b64_tr_b16 v[100:101], v10 offset:24672
    v_mfma_f32_16x16x32_bf16 v[52:55], v[128:131], v[116:119], v[52:55]
    ds_read_b64_tr_b16 v[102:103], v10 offset:25440
    ds_read_b64_tr_b16 v[104:105], v9 offset:24704
    v_mfma_f32_16x16x32_bf16 v[56:59], v[132:135], v[112:115], v[56:59]
    ds_read_b64_tr_b16 v[106:107], v9 offset:25472
    ds_read_b64_tr_b16 v[108:109], v10 offset:24736
    v_mfma_f32_16x16x32_bf16 v[60:63], v[132:135], v[116:119], v[60:63]
    ds_read_b64_tr_b16 v[110:111], v10 offset:25504
    v_mfma_f32_16x16x32_bf16 v[64:67], v[136:139], v[112:115], v[64:67]
    s_add_u32 m0, s77, 12384
    s_sub_u32 s22, s76, 8
    v_mfma_f32_16x16x32_bf16 v[68:71], v[136:139], v[116:119], v[68:71]
    buffer_load_dwordx4 v14, s[48:51], s22 offen sc1 lds
    v_mfma_f32_16x16x32_bf16 v[72:75], v[140:143], v[112:115], v[72:75]
    v_mfma_f32_16x16x32_bf16 v[76:79], v[140:143], v[116:119], v[76:79]
    s_waitcnt lgkmcnt(10)
    v_mfma_f32_16x16x32_bf16 v[32:35], v[88:91], v[80:83], v[32:35]
    ds_read_b128 v[112:115], v8 offset:32768
    ds_read_b128 v[116:119], v8 offset:34816
    v_mfma_f32_16x16x32_bf16 v[36:39], v[88:91], v[84:87], v[36:39]
    ds_read_b64_tr_b16 v[120:121], v9 offset:30720
    ds_read_b64_tr_b16 v[122:123], v9 offset:31488
    s_waitcnt lgkmcnt(12)
    v_mfma_f32_16x16x32_bf16 v[40:43], v[92:95], v[80:83], v[40:43]
    buffer_load_dwordx4 v14, s[48:51], s22 offen offset:1024 sc1 lds
    ds_read_b64_tr_b16 v[124:125], v10 offset:30752
    v_mfma_f32_16x16x32_bf16 v[44:47], v[92:95], v[84:87], v[44:47]
    ds_read_b64_tr_b16 v[126:127], v10 offset:31520
    ds_read_b64_tr_b16 v[128:129], v9 offset:30784
    s_waitcnt lgkmcnt(13)
    v_mfma_f32_16x16x32_bf16 v[48:51], v[96:99], v[80:83], v[48:51]
    ds_read_b64_tr_b16 v[130:131], v9 offset:31552
    ds_read_b64_tr_b16 v[132:133], v10 offset:30816
    v_mfma_f32_16x16x32_bf16 v[52:55], v[96:99], v[84:87], v[52:55]
    ds_read_b64_tr_b16 v[134:135], v10 offset:31584
    ds_read_b64_tr_b16 v[136:137], v9 offset:30848
    s_waitcnt lgkmcnt(15)
    v_mfma_f32_16x16x32_bf16 v[56:59], v[100:103], v[80:83], v[56:59]
    buffer_load_dwordx4 v14, s[48:51], s22 offen offset:2048 sc1 lds
    ds_read_b64_tr_b16 v[138:139], v9 offset:31616
    v_mfma_f32_16x16x32_bf16 v[60:63], v[100:103], v[84:87], v[60:63]
    ds_read_b64_tr_b16 v[140:141], v10 offset:30880
    ds_read_b64_tr_b16 v[142:143], v10 offset:31648
    s_waitcnt lgkmcnt(15)
    v_mfma_f32_16x16x32_bf16 v[64:67], v[104:107], v[80:83], v[64:67]
    v_mfma_f32_16x16x32_bf16 v[68:71], v[104:107], v[84:87], v[68:71]
    s_waitcnt lgkmcnt(14)
    v_mfma_f32_16x16x32_bf16 v[72:75], v[108:111], v[80:83], v[72:75]
    buffer_load_dwordx4 v14, s[48:51], s22 offen offset:3072 sc1 lds
    v_mfma_f32_16x16x32_bf16 v[76:79], v[108:111], v[84:87], v[76:79]
    s_waitcnt lgkmcnt(10)
    v_mfma_f32_16x16x32_bf16 v[32:35], v[120:123], v[112:115], v[32:35]
    v_mfma_f32_16x16x32_bf16 v[36:39], v[120:123], v[116:119], v[36:39]
    s_waitcnt lgkmcnt(8)
    v_mfma_f32_16x16x32_bf16 v[40:43], v[124:127], v[112:115], v[40:43]
    v_mfma_f32_16x16x32_bf16 v[44:47], v[124:127], v[116:119], v[44:47]
    s_waitcnt lgkmcnt(6)
    v_mfma_f32_16x16x32_bf16 v[48:51], v[128:131], v[112:115], v[48:51]
    v_mfma_f32_16x16x32_bf16 v[52:55], v[128:131], v[116:119], v[52:55]
    s_waitcnt lgkmcnt(4)
    v_mfma_f32_16x16x32_bf16 v[56:59], v[132:135], v[112:115], v[56:59]
    v_mfma_f32_16x16x32_bf16 v[60:63], v[132:135], v[116:119], v[60:63]
    s_waitcnt lgkmcnt(2)
    v_mfma_f32_16x16x32_bf16 v[64:67], v[136:139], v[112:115], v[64:67]
    v_mfma_f32_16x16x32_bf16 v[68:71], v[136:139], v[116:119], v[68:71]
    s_waitcnt lgkmcnt(0)
    v_mfma_f32_16x16x32_bf16 v[72:75], v[140:143], v[112:115], v[72:75]
    v_mfma_f32_16x16x32_bf16 v[76:79], v[140:143], v[116:119], v[76:79]
    s_lshl_b32 s74, s67, 3
    s_lshl_b32 s75, s64, 1
    s_add_u32 s74, s74, s75
    s_mul_i32 s74, s74, 43
    s_mul_i32 s75, s68, 3
    s_add_u32 s74, s74, s75
    s_lshl_b32 s74, s74, 10
    s_cmp_eq_u32 s68, 14
    s_cselect_b32 s75, 0x7ff00000, 0
    v_add_u32 v26, s75, v14
    v_cvt_pk_bf16_f32 v148, v32, v33
    v_cvt_pk_bf16_f32 v149, v34, v35
    v_cvt_pk_bf16_f32 v150, v40, v41
    v_cvt_pk_bf16_f32 v151, v42, v43
    v_pk_max_i16 v148, v148, 0
    v_pk_max_i16 v149, v149, 0
    v_pk_max_i16 v150, v150, 0
    v_pk_max_i16 v151, v151, 0
    s_add_u32 s75, s74, 0
    buffer_store_dwordx4 v[148:151], v14, s[60:63], s75 offen sc1
    v_cvt_pk_bf16_f32 v152, v36, v37
    v_cvt_pk_bf16_f32 v153, v38, v39
    v_cvt_pk_bf16_f32 v154, v44, v45
    v_cvt_pk_bf16_f32 v155, v46, v47
    v_pk_max_i16 v152, v152, 0
    v_pk_max_i16 v153, v153, 0
    v_pk_max_i16 v154, v154, 0
    v_pk_max_i16 v155, v155, 0
    s_add_u32 s75, s74, 44032
    buffer_store_dwordx4 v[152:155], v14, s[60:63], s75 offen sc1
    v_cvt_pk_bf16_f32 v156, v48, v49
    v_cvt_pk_bf16_f32 v157, v50, v51
    v_cvt_pk_bf16_f32 v158, v56, v57
    v_cvt_pk_bf16_f32 v159, v58, v59
    v_pk_max_i16 v156, v156, 0
    v_pk_max_i16 v157, v157, 0
    v_pk_max_i16 v158, v158, 0
    v_pk_max_i16 v159, v159, 0
    s_add_u32 s75, s74, 1024
    buffer_store_dwordx4 v[156:159], v26, s[60:63], s75 offen sc1
    v_cvt_pk_bf16_f32 v160, v52, v53
    v_cvt_pk_bf16_f32 v161, v54, v55
    v_cvt_pk_bf16_f32 v162, v60, v61
    v_cvt_pk_bf16_f32 v163, v62, v63
    v_pk_max_i16 v160, v160, 0
    v_pk_max_i16 v161, v161, 0
    v_pk_max_i16 v162, v162, 0
    v_pk_max_i16 v163, v163, 0
    s_add_u32 s75, s74, 45056
    buffer_store_dwordx4 v[160:163], v26, s[60:63], s75 offen sc1
    v_cvt_pk_bf16_f32 v148, v64, v65
    v_cvt_pk_bf16_f32 v149, v66, v67
    v_cvt_pk_bf16_f32 v150, v72, v73
    v_cvt_pk_bf16_f32 v151, v74, v75
    v_pk_max_i16 v148, v148, 0
    v_pk_max_i16 v149, v149, 0
    v_pk_max_i16 v150, v150, 0
    v_pk_max_i16 v151, v151, 0
    s_add_u32 s75, s74, 2048
    buffer_store_dwordx4 v[148:151], v26, s[60:63], s75 offen sc1
    v_cvt_pk_bf16_f32 v152, v68, v69
    v_cvt_pk_bf16_f32 v153, v70, v71
    v_cvt_pk_bf16_f32 v154, v76, v77
    v_cvt_pk_bf16_f32 v155, v78, v79
    v_pk_max_i16 v152, v152, 0
    v_pk_max_i16 v153, v153, 0
    v_pk_max_i16 v154, v154, 0
    v_pk_max_i16 v155, v155, 0
    s_add_u32 s75, s74, 46080
    buffer_store_dwordx4 v[152:155], v26, s[60:63], s75 offen sc1
    s_waitcnt vmcnt(6)
G1E_10:
    s_mul_i32 s78, s64, 20480
    s_mul_i32 s79, s64, 360448
    s_lshl_b32 s74, s73, 7
    s_add_u32 s79, s79, s74
    s_cmp_eq_u32 s64, 3
    s_cselect_b32 s77, 9, 10
    s_cselect_b32 s76, 0x7ff00000, 0
    s_lshl_b32 s77, s77, 15
    v_add_u32 v25, s76, v14
    v_mov_b32 v7, v19
    v_add_u32 v8, 7168, v19
    v_add_u32 v9, 14336, v19
    v_add_u32 v10, 21504, v19
    s_mul_i32 s75, s64, 11
    s_add_u32 s74, s64, 1
    s_and_b32 s74, s74, 3
    s_lshl_b32 s76, s72, 2
    s_add_u32 s74, s74, s76
    s_mul_i32 s74, s74, 43
    s_add_u32 s74, s74, s75
    s_lshl_b32 s82, s74, 10
    s_add_u32 s74, s64, 2
    s_and_b32 s74, s74, 3
    s_lshl_b32 s76, s72, 2
    s_add_u32 s74, s74, s76
    s_mul_i32 s74, s74, 43
    s_add_u32 s74, s74, s75
    s_lshl_b32 s83, s74, 10
    s_add_u32 s74, s64, 3
    s_and_b32 s74, s74, 3
    s_lshl_b32 s76, s72, 2
    s_add_u32 s74, s74, s76
    s_mul_i32 s74, s74, 43
    s_add_u32 s74, s74, s75
    s_lshl_b32 s84, s74, 10
    s_add_u32 s74, s64, 4
    s_and_b32 s74, s74, 3
    s_lshl_b32 s76, s72, 2
    s_add_u32 s74, s74, s76
    s_mul_i32 s74, s74, 43
    s_add_u32 s74, s74, s75
    s_lshl_b32 s85, s74, 10
    s_barrier
    ds_read_b128 v[72:75], v17 offset:0
    ds_read_b128 v[104:107], v15 offset:192
    ds_read_b128 v[76:79], v17 offset:512
    ds_read_b128 v[108:111], v16 offset:704
    ds_read_b128 v[80:83], v17 offset:1024
    ds_read_b128 v[112:115], v16 offset:1216
    ds_read_b128 v[84:87], v17 offset:1536
    ds_read_b128 v[116:119], v16 offset:1728
    ds_read_b128 v[88:91], v17 offset:2048
    ds_read_b128 v[120:123], v16 offset:2240
    ds_read_b128 v[92:95], v17 offset:2560
    ds_read_b128 v[124:127], v16 offset:2752
    ds_read_b128 v[96:99], v17 offset:3072
    ds_read_b128 v[128:131], v16 offset:3264
    ds_read_b128 v[100:103], v17 offset:3584
    ds_read_b128 v[132:135], v16 offset:3776
    s_waitcnt lgkmcnt(0)
    v_mfma_f32_16x16x32_bf16 v[40:43], v[104:107], v[72:75], 0
    ds_read_b128 v[136:139], v17 offset:64
    ds_read_b128 v[168:171], v15 offset:128
    v_mfma_f32_16x16x32_bf16 v[44:47], v[108:111], v[72:75], 0
    s_add_u32 s22, s79, 0
    s_add_u32 m0, s78, 0
    v_mfma_f32_16x16x32_bf16 v[44:47], v[104:107], v[76:79], v[44:47]
    buffer_load_dwordx4 v7, s[44:47], s22 offen lds
    ds_read_b128 v[140:143], v17 offset:576
    v_mfma_f32_16x16x32_bf16 v[48:51], v[108:111], v[76:79], 0
    ds_read_b128 v[172:175], v16 offset:640
    ds_read_b128 v[144:147], v17 offset:1088
    v_mfma_f32_16x16x32_bf16 v[48:51], v[112:115], v[72:75], v[48:51]
    ds_read_b128 v[176:179], v16 offset:1152
    ds_read_b128 v[148:151], v17 offset:1600
    v_mfma_f32_16x16x32_bf16 v[48:51], v[104:107], v[80:83], v[48:51]
    ds_read_b128 v[180:183], v16 offset:1664
    ds_read_b128 v[152:155], v17 offset:2112
    v_mfma_f32_16x16x32_bf16 v[52:55], v[112:115], v[76:79], 0
    buffer_load_dwordx4 v8, s[44:47], s22 offen offset:1024 lds
    ds_read_b128 v[184:187], v16 offset:2176
    v_mfma_f32_16x16x32_bf16 v[52:55], v[108:111], v[80:83], v[52:55]
    ds_read_b128 v[156:159], v17 offset:2624
    ds_read_b128 v[188:191], v16 offset:2688
    v_mfma_f32_16x16x32_bf16 v[56:59], v[112:115], v[80:83], 0
    ds_read_b128 v[160:163], v17 offset:3136
    ds_read_b128 v[192:195], v16 offset:3200
    v_mfma_f32_16x16x32_bf16 v[52:55], v[116:119], v[72:75], v[52:55]
    ds_read_b128 v[164:167], v17 offset:3648
    ds_read_b128 v[196:199], v16 offset:3712
    v_mfma_f32_16x16x32_bf16 v[52:55], v[104:107], v[84:87], v[52:55]
    v_mfma_f32_16x16x32_bf16 v[56:59], v[116:119], v[76:79], v[56:59]
    buffer_load_dwordx4 v9, s[44:47], s22 offen offset:2048 lds
    v_mfma_f32_16x16x32_bf16 v[56:59], v[108:111], v[84:87], v[56:59]
    v_mfma_f32_16x16x32_bf16 v[60:63], v[116:119], v[80:83], 0
    v_mfma_f32_16x16x32_bf16 v[60:63], v[112:115], v[84:87], v[60:63]
    v_mfma_f32_16x16x32_bf16 v[64:67], v[116:119], v[84:87], 0
    buffer_load_dwordx4 v10, s[44:47], s22 offen offset:3072 lds
    v_mfma_f32_16x16x32_bf16 v[56:59], v[120:123], v[72:75], v[56:59]
    v_mfma_f32_16x16x32_bf16 v[56:59], v[104:107], v[88:91], v[56:59]
    v_mfma_f32_16x16x32_bf16 v[60:63], v[120:123], v[76:79], v[60:63]
    v_mfma_f32_16x16x32_bf16 v[60:63], v[108:111], v[88:91], v[60:63]
    s_add_u32 s22, s79, 32768
    s_add_u32 m0, s78, 4096
    v_mfma_f32_16x16x32_bf16 v[64:67], v[120:123], v[80:83], v[64:67]
    buffer_load_dwordx4 v7, s[44:47], s22 offen lds
    s_waitcnt vmcnt(5)
    s_barrier
    s_cmp_lg_u32 s64, 0
    s_cbranch_scc1 PUB_17
    s_mov_b64 exec, 1
    v_mov_b32 v26, s98
    v_mov_b32 v27, s99
    s_lshl_b32 s86, s2, 7
    s_add_u32 s86, s86, 14712832
    buffer_store_dwordx2 v[26:27], off, s[48:51], s86 sc1
    s_mov_b64 exec, -1
PUB_17:
    v_mfma_f32_16x16x32_bf16 v[64:67], v[112:115], v[88:91], v[64:67]
    v_mfma_f32_16x16x32_bf16 v[68:71], v[120:123], v[84:87], 0
    v_mfma_f32_16x16x32_bf16 v[68:71], v[116:119], v[88:91], v[68:71]
    v_mfma_f32_16x16x32_bf16 v[60:63], v[124:127], v[72:75], v[60:63]
    buffer_load_dwordx4 v8, s[44:47], s22 offen offset:1024 lds
    v_mfma_f32_16x16x32_bf16 v[60:63], v[104:107], v[92:95], v[60:63]
    v_mfma_f32_16x16x32_bf16 v[64:67], v[124:127], v[76:79], v[64:67]
    v_mfma_f32_16x16x32_bf16 v[64:67], v[108:111], v[92:95], v[64:67]
    v_mfma_f32_16x16x32_bf16 v[68:71], v[124:127], v[80:83], v[68:71]
    v_mfma_f32_16x16x32_bf16 v[68:71], v[112:115], v[92:95], v[68:71]
    buffer_load_dwordx4 v9, s[44:47], s22 offen offset:2048 lds
    v_mfma_f32_16x16x32_bf16 v[64:67], v[128:131], v[72:75], v[64:67]
    v_mfma_f32_16x16x32_bf16 v[64:67], v[104:107], v[96:99], v[64:67]
    v_mfma_f32_16x16x32_bf16 v[68:71], v[128:131], v[76:79], v[68:71]
    v_mfma_f32_16x16x32_bf16 v[68:71], v[108:111], v[96:99], v[68:71]
    buffer_load_dwordx4 v10, s[44:47], s22 offen offset:3072 lds
    v_mfma_f32_16x16x32_bf16 v[68:71], v[132:135], v[72:75], v[68:71]
    v_mfma_f32_16x16x32_bf16 v[68:71], v[104:107], v[100:103], v[68:71]
    s_waitcnt lgkmcnt(0)
    v_mfma_f32_16x16x32_bf16 v[40:43], v[168:171], v[136:139], v[40:43]
    ds_read_b128 v[72:75], v17 offset:128
    ds_read_b128 v[104:107], v15 offset:64
    v_mfma_f32_16x16x32_bf16 v[44:47], v[172:175], v[136:139], v[44:47]
    s_add_u32 s22, s79, 65536
    s_add_u32 m0, s78, 8192
    v_mfma_f32_16x16x32_bf16 v[44:47], v[168:171], v[140:143], v[44:47]
    buffer_load_dwordx4 v7, s[44:47], s22 offen lds
    ds_read_b128 v[76:79], v17 offset:640
    v_mfma_f32_16x16x32_bf16 v[48:51], v[172:175], v[140:143], v[48:51]
    ds_read_b128 v[108:111], v16 offset:576
    ds_read_b128 v[80:83], v17 offset:1152
    v_mfma_f32_16x16x32_bf16 v[48:51], v[176:179], v[136:139], v[48:51]
    ds_read_b128 v[112:115], v16 offset:1088
    ds_read_b128 v[84:87], v17 offset:1664
    v_mfma_f32_16x16x32_bf16 v[48:51], v[168:171], v[144:147], v[48:51]
    ds_read_b128 v[116:119], v16 offset:1600
    ds_read_b128 v[88:91], v17 offset:2176
    v_mfma_f32_16x16x32_bf16 v[52:55], v[176:179], v[140:143], v[52:55]
    buffer_load_dwordx4 v8, s[44:47], s22 offen offset:1024 lds
    ds_read_b128 v[120:123], v16 offset:2112
    v_mfma_f32_16x16x32_bf16 v[52:55], v[172:175], v[144:147], v[52:55]
    ds_read_b128 v[92:95], v17 offset:2688
    ds_read_b128 v[124:127], v16 offset:2624
    v_mfma_f32_16x16x32_bf16 v[56:59], v[176:179], v[144:147], v[56:59]
    ds_read_b128 v[96:99], v17 offset:3200
    ds_read_b128 v[128:131], v16 offset:3136
    v_mfma_f32_16x16x32_bf16 v[52:55], v[180:183], v[136:139], v[52:55]
    ds_read_b128 v[100:103], v17 offset:3712
    ds_read_b128 v[132:135], v16 offset:3648
    v_mfma_f32_16x16x32_bf16 v[52:55], v[168:171], v[148:151], v[52:55]
    v_mfma_f32_16x16x32_bf16 v[56:59], v[180:183], v[140:143], v[56:59]
    buffer_load_dwordx4 v9, s[44:47], s22 offen offset:2048 lds
    v_mfma_f32_16x16x32_bf16 v[56:59], v[172:175], v[148:151], v[56:59]
    v_mfma_f32_16x16x32_bf16 v[60:63], v[180:183], v[144:147], v[60:63]
    v_mfma_f32_16x16x32_bf16 v[60:63], v[176:179], v[148:151], v[60:63]
    v_mfma_f32_16x16x32_bf16 v[64:67], v[180:183], v[148:151], v[64:67]
    buffer_load_dwordx4 v10, s[44:47], s22 offen offset:3072 lds
    v_mfma_f32_16x16x32_bf16 v[56:59], v[184:187], v[136:139], v[56:59]
    v_mfma_f32_16x16x32_bf16 v[56:59], v[168:171], v[152:155], v[56:59]
    v_mfma_f32_16x16x32_bf16 v[60:63], v[184:187], v[140:143], v[60:63]
    v_mfma_f32_16x16x32_bf16 v[60:63], v[172:175], v[152:155], v[60:63]
    s_add_u32 s22, s79, 98304
    s_add_u32 m0, s78, 12288
    v_mfma_f32_16x16x32_bf16 v[64:67], v[184:187], v[144:147], v[64:67]
    buffer_load_dwordx4 v7, s[44:47], s22 offen lds
    v_mfma_f32_16x16x32_bf16 v[64:67], v[176:179], v[152:155], v[64:67]
    v_mfma_f32_16x16x32_bf16 v[68:71], v[184:187], v[148:151], v[68:71]
    v_mfma_f32_16x16x32_bf16 v[68:71], v[180:183], v[152:155], v[68:71]
    v_mfma_f32_16x16x32_bf16 v[60:63], v[188:191], v[136:139], v[60:63]
    buffer_load_dwordx4 v8, s[44:47], s22 offen offset:1024 lds
    v_mfma_f32_16x16x32_bf16 v[60:63], v[168:171], v[156:159], v[60:63]
    v_mfma_f32_16x16x32_bf16 v[64:67], v[188:191], v[140:143], v[64:67]
    v_mfma_f32_16x16x32_bf16 v[64:67], v[172:175], v[156:159], v[64:67]
    s_waitcnt vmcnt(10)
    ds_read_b64_tr_b16 a[0:1], v20 offset:0
    v_mfma_f32_16x16x32_bf16 v[68:71], v[188:191], v[144:147], v[68:71]
    ds_read_b64_tr_b16 a[2:3], v20 offset:2048
    ds_read_b64_tr_b16 a[4:5], v21 offset:0
    v_mfma_f32_16x16x32_bf16 v[68:71], v[176:179], v[156:159], v[68:71]
    buffer_load_dwordx4 v9, s[44:47], s22 offen offset:2048 lds
    ds_read_b64_tr_b16 a[6:7], v21 offset:2048
    v_mfma_f32_16x16x32_bf16 v[64:67], v[192:195], v[136:139], v[64:67]
    ds_read_b64_tr_b16 a[8:9], v22 offset:0
    ds_read_b64_tr_b16 a[10:11], v22 offset:2048
    v_mfma_f32_16x16x32_bf16 v[64:67], v[168:171], v[160:163], v[64:67]
    ds_read_b64_tr_b16 a[12:13], v23 offset:0
    ds_read_b64_tr_b16 a[14:15], v23 offset:2048
    v_mfma_f32_16x16x32_bf16 v[68:71], v[192:195], v[140:143], v[68:71]
    v_mfma_f32_16x16x32_bf16 v[68:71], v[172:175], v[160:163], v[68:71]
    buffer_load_dwordx4 v10, s[44:47], s22 offen offset:3072 lds
    v_mfma_f32_16x16x32_bf16 v[68:71], v[196:199], v[136:139], v[68:71]
    v_mfma_f32_16x16x32_bf16 v[68:71], v[168:171], v[164:167], v[68:71]
    s_waitcnt lgkmcnt(8)
    v_mfma_f32_16x16x32_bf16 v[40:43], v[104:107], v[72:75], v[40:43]
    ds_read_b128 v[136:139], v17 offset:192
    ds_read_b128 v[168:171], v15 offset:0
    v_mfma_f32_16x16x32_bf16 v[44:47], v[108:111], v[72:75], v[44:47]
    s_add_u32 s22, s79, 131072
    s_add_u32 m0, s78, 16384
    v_mfma_f32_16x16x32_bf16 v[44:47], v[104:107], v[76:79], v[44:47]
    buffer_load_dwordx4 v7, s[44:47], s22 offen lds
    ds_read_b128 v[140:143], v17 offset:704
    v_mfma_f32_16x16x32_bf16 v[48:51], v[108:111], v[76:79], v[48:51]
    ds_read_b128 v[172:175], v16 offset:512
    ds_read_b128 v[144:147], v17 offset:1216
    v_mfma_f32_16x16x32_bf16 v[48:51], v[112:115], v[72:75], v[48:51]
    buffer_load_dwordx2 v[26:27], v12, s[48:51], 0 offen sc1
    ds_read_b128 v[176:179], v16 offset:1024
    v_mfma_f32_16x16x32_bf16 v[48:51], v[104:107], v[80:83], v[48:51]
    ds_read_b128 v[148:151], v17 offset:1728
    ds_read_b128 v[180:183], v16 offset:1536
    v_mfma_f32_16x16x32_bf16 v[52:55], v[112:115], v[76:79], v[52:55]
    buffer_load_dwordx4 v8, s[44:47], s22 offen offset:1024 lds
    ds_read_b128 v[152:155], v17 offset:2240
    v_mfma_f32_16x16x32_bf16 v[52:55], v[108:111], v[80:83], v[52:55]
    ds_read_b128 v[184:187], v16 offset:2048
    ds_read_b128 v[156:159], v17 offset:2752
    v_mfma_f32_16x16x32_bf16 v[56:59], v[112:115], v[80:83], v[56:59]
    ds_read_b128 v[188:191], v16 offset:2560
    ds_read_b128 v[160:163], v17 offset:3264
    v_mfma_f32_16x16x32_bf16 v[52:55], v[116:119], v[72:75], v[52:55]
    ds_read_b128 v[192:195], v16 offset:3072
    ds_read_b128 v[164:167], v17 offset:3776
    v_mfma_f32_16x16x32_bf16 v[52:55], v[104:107], v[84:87], v[52:55]
    ds_read_b128 v[196:199], v16 offset:3584
    s_waitcnt vmcnt(11)
    v_mfma_f32_16x16x32_bf16 v[56:59], v[116:119], v[76:79], v[56:59]
    buffer_load_dwordx4 v9, s[44:47], s22 offen offset:2048 lds
    ds_read_b64_tr_b16 a[16:17], v20 offset:4096
    v_mfma_f32_16x16x32_bf16 v[56:59], v[108:111], v[84:87], v[56:59]
    ds_read_b64_tr_b16 a[18:19], v20 offset:6144
    ds_read_b64_tr_b16 a[20:21], v21 offset:4096
    v_mfma_f32_16x16x32_bf16 v[60:63], v[116:119], v[80:83], v[60:63]
    ds_read_b64_tr_b16 a[22:23], v21 offset:6144
    ds_read_b64_tr_b16 a[24:25], v22 offset:4096
    v_mfma_f32_16x16x32_bf16 v[60:63], v[112:115], v[84:87], v[60:63]
    ds_read_b64_tr_b16 a[26:27], v22 offset:6144
    ds_read_b64_tr_b16 a[28:29], v23 offset:4096
    v_mfma_f32_16x16x32_bf16 v[64:67], v[116:119], v[84:87], v[64:67]
    buffer_load_dwordx4 v10, s[44:47], s22 offen offset:3072 lds
    ds_read_b64_tr_b16 a[30:31], v23 offset:6144
    v_mfma_f32_16x16x32_bf16 v[56:59], v[120:123], v[72:75], v[56:59]
    v_mfma_f32_16x16x32_bf16 v[56:59], v[104:107], v[88:91], v[56:59]
    v_mfma_f32_16x16x32_bf16 v[60:63], v[120:123], v[76:79], v[60:63]
    v_mfma_f32_16x16x32_bf16 v[60:63], v[108:111], v[88:91], v[60:63]
    s_waitcnt lgkmcnt(15)
    s_add_u32 s22, s79, 163840
    s_add_u32 m0, s78, 0
    v_mfma_f32_16x16x32_bf16 v[64:67], v[120:123], v[80:83], v[64:67]
    buffer_load_dwordx4 v7, s[44:47], s22 offen lds
    v_mfma_f32_16x16x32_bf16 v[64:67], v[112:115], v[88:91], v[64:67]
    v_mfma_f32_16x16x32_bf16 v[68:71], v[120:123], v[84:87], v[68:71]
    v_mfma_f32_16x16x32_bf16 v[68:71], v[116:119], v[88:91], v[68:71]
    v_mfma_f32_16x16x32_bf16 v[60:63], v[124:127], v[72:75], v[60:63]
    buffer_load_dwordx4 v8, s[44:47], s22 offen offset:1024 lds
    v_mfma_f32_16x16x32_bf16 v[60:63], v[104:107], v[92:95], v[60:63]
    v_mfma_f32_16x16x32_bf16 v[64:67], v[124:127], v[76:79], v[64:67]
    v_mfma_f32_16x16x32_bf16 v[64:67], v[108:111], v[92:95], v[64:67]
    s_waitcnt vmcnt(11)
    ds_read_b64_tr_b16 a[32:33], v20 offset:8192
    v_mfma_f32_16x16x32_bf16 v[68:71], v[124:127], v[80:83], v[68:71]
    ds_read_b64_tr_b16 a[34:35], v20 offset:10240
    ds_read_b64_tr_b16 a[36:37], v21 offset:8192
    v_mfma_f32_16x16x32_bf16 v[68:71], v[112:115], v[92:95], v[68:71]
    buffer_load_dwordx4 v9, s[44:47], s22 offen offset:2048 lds
    ds_read_b64_tr_b16 a[38:39], v21 offset:10240
    v_mfma_f32_16x16x32_bf16 v[64:67], v[128:131], v[72:75], v[64:67]
    ds_read_b64_tr_b16 a[40:41], v22 offset:8192
    ds_read_b64_tr_b16 a[42:43], v22 offset:10240
    v_mfma_f32_16x16x32_bf16 v[64:67], v[104:107], v[96:99], v[64:67]
    ds_read_b64_tr_b16 a[44:45], v23 offset:8192
    ds_read_b64_tr_b16 a[46:47], v23 offset:10240
    v_mfma_f32_16x16x32_bf16 v[68:71], v[128:131], v[76:79], v[68:71]
    v_mfma_f32_16x16x32_bf16 v[68:71], v[108:111], v[96:99], v[68:71]
    buffer_load_dwordx4 v10, s[44:47], s22 offen offset:3072 lds
    v_mfma_f32_16x16x32_bf16 v[68:71], v[132:135], v[72:75], v[68:71]
    v_mfma_f32_16x16x32_bf16 v[68:71], v[104:107], v[100:103], v[68:71]
    s_waitcnt lgkmcnt(15)
    v_mfma_f32_16x16x32_bf16 v[40:43], v[168:171], v[136:139], v[40:43]
    v_mfma_f32_16x16x32_bf16 v[44:47], v[172:175], v[136:139], v[44:47]
    s_waitcnt lgkmcnt(8)
    s_add_u32 s22, s79, 196608
    s_add_u32 m0, s78, 4096
    v_mfma_f32_16x16x32_bf16 v[44:47], v[168:171], v[140:143], v[44:47]
    buffer_load_dwordx4 v7, s[44:47], s22 offen lds
    v_mfma_f32_16x16x32_bf16 v[48:51], v[172:175], v[140:143], v[48:51]
    v_mfma_f32_16x16x32_bf16 v[48:51], v[176:179], v[136:139], v[48:51]
    v_mfma_f32_16x16x32_bf16 v[48:51], v[168:171], v[144:147], v[48:51]
    v_mfma_f32_16x16x32_bf16 v[52:55], v[176:179], v[140:143], v[52:55]
    buffer_load_dwordx4 v8, s[44:47], s22 offen offset:1024 lds
    v_mfma_f32_16x16x32_bf16 v[52:55], v[172:175], v[144:147], v[52:55]
    v_mfma_f32_16x16x32_bf16 v[56:59], v[176:179], v[144:147], v[56:59]
    v_mfma_f32_16x16x32_bf16 v[52:55], v[180:183], v[136:139], v[52:55]
    s_waitcnt vmcnt(11)
    ds_read_b64_tr_b16 a[48:49], v20 offset:12288
    v_mfma_f32_16x16x32_bf16 v[52:55], v[168:171], v[148:151], v[52:55]
    ds_read_b64_tr_b16 a[50:51], v20 offset:14336
    ds_read_b64_tr_b16 a[52:53], v21 offset:12288
    v_mfma_f32_16x16x32_bf16 v[56:59], v[180:183], v[140:143], v[56:59]
    buffer_load_dwordx4 v9, s[44:47], s22 offen offset:2048 lds
    ds_read_b64_tr_b16 a[54:55], v21 offset:14336
    v_mfma_f32_16x16x32_bf16 v[56:59], v[172:175], v[148:151], v[56:59]
    ds_read_b64_tr_b16 a[56:57], v22 offset:12288
    ds_read_b64_tr_b16 a[58:59], v22 offset:14336
    v_mfma_f32_16x16x32_bf16 v[60:63], v[180:183], v[144:147], v[60:63]
    ds_read_b64_tr_b16 a[60:61], v23 offset:12288
    ds_read_b64_tr_b16 a[62:63], v23 offset:14336
    v_mfma_f32_16x16x32_bf16 v[60:63], v[176:179], v[148:151], v[60:63]
    v_mfma_f32_16x16x32_bf16 v[64:67], v[180:183], v[148:151], v[64:67]
    buffer_load_dwordx4 v10, s[44:47], s22 offen offset:3072 lds
    v_mfma_f32_16x16x32_bf16 v[56:59], v[184:187], v[136:139], v[56:59]
    v_mfma_f32_16x16x32_bf16 v[56:59], v[168:171], v[152:155], v[56:59]
    v_mfma_f32_16x16x32_bf16 v[60:63], v[184:187], v[140:143], v[60:63]
    v_mfma_f32_16x16x32_bf16 v[60:63], v[172:175], v[152:155], v[60:63]
    s_waitcnt lgkmcnt(8)
    s_add_u32 s22, s79, 229376
    s_add_u32 m0, s78, 8192
    v_mfma_f32_16x16x32_bf16 v[64:67], v[184:187], v[144:147], v[64:67]
    buffer_load_dwordx4 v7, s[44:47], s22 offen lds
    v_mfma_f32_16x16x32_bf16 v[64:67], v[176:179], v[152:155], v[64:67]
    v_mfma_f32_16x16x32_bf16 v[68:71], v[184:187], v[148:151], v[68:71]
    v_mfma_f32_16x16x32_bf16 v[68:71], v[180:183], v[152:155], v[68:71]
    v_mfma_f32_16x16x32_bf16 v[60:63], v[188:191], v[136:139], v[60:63]
    buffer_load_dwordx4 v8, s[44:47], s22 offen offset:1024 lds
    v_mfma_f32_16x16x32_bf16 v[60:63], v[168:171], v[156:159], v[60:63]
    v_mfma_f32_16x16x32_bf16 v[64:67], v[188:191], v[140:143], v[64:67]
    v_mfma_f32_16x16x32_bf16 v[64:67], v[172:175], v[156:159], v[64:67]
    s_waitcnt vmcnt(10)
    ds_read_b64_tr_b16 a[64:65], v20 offset:16384
    v_mfma_f32_16x16x32_bf16 v[68:71], v[188:191], v[144:147], v[68:71]
    ds_read_b64_tr_b16 a[66:67], v20 offset:18432
    ds_read_b64_tr_b16 a[68:69], v21 offset:16384
    v_mfma_f32_16x16x32_bf16 v[68:71], v[176:179], v[156:159], v[68:71]
    buffer_load_dwordx4 v9, s[44:47], s22 offen offset:2048 lds
    ds_read_b64_tr_b16 a[70:71], v21 offset:18432
    v_mfma_f32_16x16x32_bf16 v[64:67], v[192:195], v[136:139], v[64:67]
    ds_read_b64_tr_b16 a[72:73], v22 offset:16384
    ds_read_b64_tr_b16 a[74:75], v22 offset:18432
    v_mfma_f32_16x16x32_bf16 v[64:67], v[168:171], v[160:163], v[64:67]
    ds_read_b64_tr_b16 a[76:77], v23 offset:16384
    ds_read_b64_tr_b16 a[78:79], v23 offset:18432
    v_mfma_f32_16x16x32_bf16 v[68:71], v[192:195], v[140:143], v[68:71]
    v_cmp_ne_u64 vcc, s[98:99], v[26:27]
    s_cbranch_vccz POLLD_19
    s_mov_b32 s86, 4000
POLL_18:
    s_sleep 2
    buffer_load_dwordx2 v[26:27], v12, s[48:51], 0 offen sc1
    s_waitcnt vmcnt(0)
    v_cmp_ne_u64 vcc, s[98:99], v[26:27]
    s_cbranch_vccz POLLD_19
    s_sub_u32 s86, s86, 1
    s_cmp_lg_u32 s86, 0
    s_cbranch_scc1 POLL_18
POLLD_19:
    v_mfma_f32_16x16x32_bf16 v[68:71], v[172:175], v[160:163], v[68:71]
    buffer_load_dwordx4 v10, s[44:47], s22 offen offset:3072 lds
    v_mfma_f32_16x16x32_bf16 v[68:71], v[196:199], v[136:139], v[68:71]
    v_mfma_f32_16x16x32_bf16 v[68:71], v[168:171], v[164:167], v[68:71]
    ds_read_b64 v[248:249], v18 offset:0
    ds_read_b64 v[250:251], v18 offset:512
    ds_read_b64 v[252:253], v18 offset:1024
    ds_read_b64 v[254:255], v18 offset:1536
    s_add_u32 s21, s82, 0
    buffer_load_dwordx4 v[72:75], v14, s[60:63], s21 offen sc1
    buffer_load_dwordx4 v[76:79], v14, s[60:63], s21 offen offset:1024 sc1
    s_waitcnt lgkmcnt(0)
    s_barrier
    buffer_load_dwordx4 v[80:83], v14, s[60:63], s21 offen offset:2048 sc1
    buffer_load_dwordx4 v[84:87], v14, s[60:63], s21 offen offset:3072 sc1
    s_and_b32 s75, s64, 1
    s_lshl_b32 s74, s64, 12
    s_add_u32 s74, s74, 135168
    v_add_u32 v2, s74, v14
    s_xor_b32 s74, s64, 1
    s_lshl_b32 s74, s74, 12
    s_add_u32 s74, s74, 135168
    v_add_u32 v3, s74, v14
    s_cmp_eq_u32 s75, 0
    s_cbranch_scc0 XA_20
    ds_write_b128 v2, v[56:59] offset:0
    ds_write_b128 v2, v[60:63] offset:1024
    ds_write_b128 v2, v[64:67] offset:2048
    ds_write_b128 v2, v[68:71] offset:3072
    s_branch XB_21
XA_20:
    ds_write_b128 v2, v[40:43] offset:0
    ds_write_b128 v2, v[44:47] offset:1024
    ds_write_b128 v2, v[48:51] offset:2048
    ds_write_b128 v2, v[52:55] offset:3072
    v_mov_b32 v40, v56
    v_mov_b32 v41, v57
    v_mov_b32 v42, v58
    v_mov_b32 v43, v59
    v_mov_b32 v44, v60
    v_mov_b32 v45, v61
    v_mov_b32 v46, v62
    v_mov_b32 v47, v63
    v_mov_b32 v48, v64
    v_mov_b32 v49, v65
    v_mov_b32 v50, v66
    v_mov_b32 v51, v67
    v_mov_b32 v52, v68
    v_mov_b32 v53, v69
    v_mov_b32 v54, v70
    v_mov_b32 v55, v71
XB_21:
    s_waitcnt vmcnt(12)
    ds_read_b64_tr_b16 a[80:81], v20 offset:0
    ds_read_b64_tr_b16 a[82:83], v20 offset:2048
    ds_read_b64_tr_b16 a[84:85], v21 offset:0
    ds_read_b64_tr_b16 a[86:87], v21 offset:2048
    ds_read_b64_tr_b16 a[88:89], v22 offset:0
    ds_read_b64_tr_b16 a[90:91], v22 offset:2048
    ds_read_b64_tr_b16 a[92:93], v23 offset:0
    ds_read_b64_tr_b16 a[94:95], v23 offset:2048
    s_add_u32 s22, s79, 262144
    s_add_u32 m0, s78, 12288
    s_nop 0
    buffer_load_dwordx4 v7, s[44:47], s22 offen lds
    buffer_load_dwordx4 v8, s[44:47], s22 offen offset:1024 lds
    buffer_load_dwordx4 v9, s[44:47], s22 offen offset:2048 lds
    s_waitcnt lgkmcnt(0)
    s_barrier
    ds_read_b128 v[56:59], v3 offset:0
    ds_read_b128 v[60:63], v3 offset:1024
    ds_read_b128 v[64:67], v3 offset:2048
    ds_read_b128 v[68:71], v3 offset:3072
    buffer_load_dwordx4 v10, s[44:47], s22 offen offset:3072 lds
    s_add_u32 s21, s82, 4096
    buffer_load_dwordx4 v[88:91], v14, s[60:63], s21 offen sc1
    s_lshr_b32 s74, s64, 1
    s_add_u32 s74, s74, s71
    s_lshl_b32 s74, s74, 12
    s_lshl_b32 s75, s75, 11
    s_add_u32 s74, s74, s75
    s_add_u32 s74, s74, 10485760
    v_lshrrev_b32 v4, 4, v1
    v_and_b32 v5, 1, v4
    v_lshrrev_b32 v4, 1, v4
    v_lshlrev_b32 v4, 8, v4
    v_lshl_add_u32 v4, v5, 9, v4
    v_and_b32 v5, 15, v1
    v_lshl_add_u32 v4, v5, 4, v4
    s_mov_b32 s92, 0xffff0000
    s_waitcnt lgkmcnt(3)
    v_pk_add_f32 v[40:41], v[40:41], v[56:57]
    v_pk_add_f32 v[42:43], v[42:43], v[58:59]
    buffer_load_dwordx4 v[92:95], v14, s[60:63], s21 offen offset:1024 sc1
    v_lshlrev_b32 v56, 16, v248
    v_and_b32 v57, s92, v248
    v_lshlrev_b32 v58, 16, v249
    v_and_b32 v59, s92, v249
    buffer_load_dwordx4 v[96:99], v14, s[60:63], s21 offen offset:2048 sc1
    v_fma_f32 v40, v24, v56, v40
    v_fma_f32 v41, v24, v57, v41
    v_fma_f32 v42, v24, v58, v42
    v_fma_f32 v43, v24, v59, v43
    buffer_load_dwordx4 v[100:103], v14, s[60:63], s21 offen offset:3072 sc1
    s_waitcnt vmcnt(16)
    ds_read_b64_tr_b16 a[96:97], v20 offset:4096
    ds_read_b64_tr_b16 a[98:99], v20 offset:6144
    ds_read_b64_tr_b16 a[100:101], v21 offset:4096
    ds_read_b64_tr_b16 a[102:103], v21 offset:6144
    ds_read_b64_tr_b16 a[104:105], v22 offset:4096
    ds_read_b64_tr_b16 a[106:107], v22 offset:6144
    ds_read_b64_tr_b16 a[108:109], v23 offset:4096
    ds_read_b64_tr_b16 a[110:111], v23 offset:6144
    s_add_u32 s22, s79, 294912
    s_add_u32 m0, s78, 16384
    s_nop 0
    buffer_load_dwordx4 v7, s[44:47], s22 offen lds
    s_waitcnt lgkmcnt(10)
    v_pk_add_f32 v[44:45], v[44:45], v[60:61]
    v_pk_add_f32 v[46:47], v[46:47], v[62:63]
    buffer_load_dwordx4 v8, s[44:47], s22 offen offset:1024 lds
    v_lshlrev_b32 v60, 16, v250
    v_and_b32 v61, s92, v250
    v_lshlrev_b32 v62, 16, v251
    v_and_b32 v63, s92, v251
    buffer_load_dwordx4 v9, s[44:47], s22 offen offset:2048 lds
    v_fma_f32 v44, v24, v60, v44
    v_fma_f32 v45, v24, v61, v45
    v_fma_f32 v46, v24, v62, v46
    v_fma_f32 v47, v24, v63, v47
    buffer_load_dwordx4 v10, s[44:47], s22 offen offset:3072 lds
    s_add_u32 s21, s82, 8192
    buffer_load_dwordx4 v[104:107], v14, s[60:63], s21 offen sc1
    s_waitcnt lgkmcnt(9)
    v_pk_add_f32 v[48:49], v[48:49], v[64:65]
    v_pk_add_f32 v[50:51], v[50:51], v[66:67]
    buffer_load_dwordx4 v[108:111], v14, s[60:63], s21 offen offset:1024 sc1
    v_lshlrev_b32 v64, 16, v252
    v_and_b32 v65, s92, v252
    v_lshlrev_b32 v66, 16, v253
    v_and_b32 v67, s92, v253
    buffer_load_dwordx4 v[112:115], v25, s[60:63], s21 offen offset:2048 sc1
    v_fma_f32 v48, v24, v64, v48
    v_fma_f32 v49, v24, v65, v49
    v_fma_f32 v50, v24, v66, v50
    v_fma_f32 v51, v24, v67, v51
    s_waitcnt vmcnt(19)
    ds_read_b64_tr_b16 a[112:113], v20 offset:8192
    ds_read_b64_tr_b16 a[114:115], v20 offset:10240
    ds_read_b64_tr_b16 a[116:117], v21 offset:8192
    ds_read_b64_tr_b16 a[118:119], v21 offset:10240
    ds_read_b64_tr_b16 a[120:121], v22 offset:8192
    ds_read_b64_tr_b16 a[122:123], v22 offset:10240
    ds_read_b64_tr_b16 a[124:125], v23 offset:8192
    ds_read_b64_tr_b16 a[126:127], v23 offset:10240
    s_add_u32 s22, s79, s77
    s_add_u32 m0, s78, 0
    s_nop 0
    buffer_load_dwordx4 v7, s[44:47], s22 offen lds
    buffer_load_dwordx4 v8, s[44:47], s22 offen offset:1024 lds
    s_waitcnt lgkmcnt(15)
    v_pk_add_f32 v[52:53], v[52:53], v[68:69]
    v_pk_add_f32 v[54:55], v[54:55], v[70:71]
    buffer_load_dwordx4 v9, s[44:47], s22 offen offset:2048 lds
    v_lshlrev_b32 v68, 16, v254
    v_and_b32 v69, s92, v254
    v_lshlrev_b32 v70, 16, v255
    v_and_b32 v71, s92, v255
    buffer_load_dwordx4 v10, s[44:47], s22 offen offset:3072 lds
    v_fma_f32 v52, v24, v68, v52
    v_fma_f32 v53, v24, v69, v53
    v_fma_f32 v54, v24, v70, v54
    v_fma_f32 v55, v24, v71, v55
    s_add_u32 s21, s83, 0
    buffer_load_dwordx4 v[116:119], v14, s[60:63], s21 offen sc1
    buffer_load_dwordx4 v[120:123], v14, s[60:63], s21 offen offset:1024 sc1
    v_cvt_pk_bf16_f32 v56, v40, v41
    v_cvt_pk_bf16_f32 v57, v42, v43
    v_cvt_pk_bf16_f32 v58, v44, v45
    v_cvt_pk_bf16_f32 v59, v46, v47
    s_nop 0
    v_permlane16_swap_b32 v56, v58
    v_permlane16_swap_b32 v57, v59
    s_add_u32 s75, s74, 0
    buffer_store_dwordx4 v[56:59], v4, s[48:51], s75 offen sc1
    v_cvt_pk_bf16_f32 v60, v48, v49
    v_cvt_pk_bf16_f32 v61, v50, v51
    v_cvt_pk_bf16_f32 v62, v52, v53
    v_cvt_pk_bf16_f32 v63, v54, v55
    s_nop 0
    v_permlane16_swap_b32 v60, v62
    v_permlane16_swap_b32 v61, v63
    s_add_u32 s75, s74, 1024
    buffer_store_dwordx4 v[60:63], v4, s[48:51], s75 offen sc1
    buffer_load_dwordx4 v[124:127], v14, s[60:63], s21 offen offset:2048 sc1
    buffer_load_dwordx4 v[128:131], v14, s[60:63], s21 offen offset:3072 sc1
    s_lshl_b32 s74, s72, 6
    s_lshl_b32 s75, s64, 4
    s_add_u32 s74, s74, s75
    s_lshl_b32 s74, s74, 2
    s_add_u32 s74, s74, 12582912
    v_and_b32 v2, 15, v1
    v_lshlrev_b32 v2, 2, v2
    buffer_load_dword v3, v2, s[48:51], s74 offen sc1
    s_add_u32 s74, s64, 1
    v_add_u32 v5, 86016, v14
    s_waitcnt vmcnt(29)
    v_mfma_f32_16x16x32_bf16 a[176:179], a[0:3], v[72:75], 0
    v_mfma_f32_16x16x32_bf16 a[180:183], a[4:7], v[72:75], 0
    s_add_u32 s21, s83, 4096
    s_waitcnt vmcnt(22)
    v_mfma_f32_16x16x32_bf16 a[184:187], a[8:11], v[72:75], 0
    buffer_load_dwordx4 v[132:135], v14, s[60:63], s21 offen sc1
    ds_read_b64_tr_b16 a[128:129], v20 offset:12288
    v_mfma_f32_16x16x32_bf16 a[188:191], a[12:15], v[72:75], 0
    ds_read_b64_tr_b16 a[130:131], v20 offset:14336
    ds_read_b64_tr_b16 a[132:133], v21 offset:12288
    v_mfma_f32_16x16x32_bf16 a[176:179], a[16:19], v[76:79], a[176:179]
    ds_read_b64_tr_b16 a[134:135], v21 offset:14336
    ds_read_b64_tr_b16 a[136:137], v22 offset:12288
    v_mfma_f32_16x16x32_bf16 a[180:183], a[20:23], v[76:79], a[180:183]
    ds_read_b64_tr_b16 a[138:139], v22 offset:14336
    ds_read_b64_tr_b16 a[140:141], v23 offset:12288
    v_mfma_f32_16x16x32_bf16 a[184:187], a[24:27], v[76:79], a[184:187]
    buffer_load_dwordx4 v[136:139], v14, s[60:63], s21 offen offset:1024 sc1
    ds_read_b64_tr_b16 a[142:143], v23 offset:14336
    v_mfma_f32_16x16x32_bf16 a[188:191], a[28:31], v[76:79], a[188:191]
    v_mfma_f32_16x16x32_bf16 a[176:179], a[32:35], v[80:83], a[176:179]
    v_mfma_f32_16x16x32_bf16 a[180:183], a[36:39], v[80:83], a[180:183]
    v_mfma_f32_16x16x32_bf16 a[184:187], a[40:43], v[80:83], a[184:187]
    s_waitcnt vmcnt(16)
    ds_read_b64_tr_b16 a[144:145], v20 offset:16384
    v_mfma_f32_16x16x32_bf16 a[188:191], a[44:47], v[80:83], a[188:191]
    buffer_load_dwordx4 v[140:143], v14, s[60:63], s21 offen offset:2048 sc1
    ds_read_b64_tr_b16 a[146:147], v20 offset:18432
    v_mfma_f32_16x16x32_bf16 a[176:179], a[48:51], v[84:87], a[176:179]
    ds_read_b64_tr_b16 a[148:149], v21 offset:16384
    ds_read_b64_tr_b16 a[150:151], v21 offset:18432
    v_mfma_f32_16x16x32_bf16 a[180:183], a[52:55], v[84:87], a[180:183]
    ds_read_b64_tr_b16 a[152:153], v22 offset:16384
    ds_read_b64_tr_b16 a[154:155], v22 offset:18432
    v_mfma_f32_16x16x32_bf16 a[184:187], a[56:59], v[84:87], a[184:187]
    ds_read_b64_tr_b16 a[156:157], v23 offset:16384
    ds_read_b64_tr_b16 a[158:159], v23 offset:18432
    v_mfma_f32_16x16x32_bf16 a[188:191], a[60:63], v[84:87], a[188:191]
    buffer_load_dwordx4 v[144:147], v14, s[60:63], s21 offen offset:3072 sc1
    v_mfma_f32_16x16x32_bf16 a[176:179], a[64:67], v[88:91], a[176:179]
    v_mfma_f32_16x16x32_bf16 a[180:183], a[68:71], v[88:91], a[180:183]
    v_mfma_f32_16x16x32_bf16 a[184:187], a[72:75], v[88:91], a[184:187]
    v_mfma_f32_16x16x32_bf16 a[188:191], a[76:79], v[88:91], a[188:191]
    s_add_u32 s21, s83, 8192
    s_waitcnt vmcnt(11)
    v_mfma_f32_16x16x32_bf16 a[176:179], a[80:83], v[92:95], a[176:179]
    buffer_load_dwordx4 v[148:151], v14, s[60:63], s21 offen sc1
    ds_read_b64_tr_b16 a[160:161], v20 offset:0
    v_mfma_f32_16x16x32_bf16 a[180:183], a[84:87], v[92:95], a[180:183]
    ds_read_b64_tr_b16 a[162:163], v20 offset:2048
    ds_read_b64_tr_b16 a[164:165], v21 offset:0
    v_mfma_f32_16x16x32_bf16 a[184:187], a[88:91], v[92:95], a[184:187]
    ds_read_b64_tr_b16 a[166:167], v21 offset:2048
    ds_read_b64_tr_b16 a[168:169], v22 offset:0
    v_mfma_f32_16x16x32_bf16 a[188:191], a[92:95], v[92:95], a[188:191]
    ds_read_b64_tr_b16 a[170:171], v22 offset:2048
    ds_read_b64_tr_b16 a[172:173], v23 offset:0
    s_waitcnt lgkmcnt(15)
    v_mfma_f32_16x16x32_bf16 a[176:179], a[96:99], v[96:99], a[176:179]
    buffer_load_dwordx4 v[152:155], v14, s[60:63], s21 offen offset:1024 sc1
    ds_read_b64_tr_b16 a[174:175], v23 offset:2048
    v_mfma_f32_16x16x32_bf16 a[180:183], a[100:103], v[96:99], a[180:183]
    v_mfma_f32_16x16x32_bf16 a[184:187], a[104:107], v[96:99], a[184:187]
    v_mfma_f32_16x16x32_bf16 a[188:191], a[108:111], v[96:99], a[188:191]
    v_mfma_f32_16x16x32_bf16 a[176:179], a[112:115], v[100:103], a[176:179]
    buffer_load_dwordx4 v[156:159], v25, s[60:63], s21 offen offset:2048 sc1
    v_mfma_f32_16x16x32_bf16 a[180:183], a[116:119], v[100:103], a[180:183]
    v_mfma_f32_16x16x32_bf16 a[184:187], a[120:123], v[100:103], a[184:187]
    v_mfma_f32_16x16x32_bf16 a[188:191], a[124:127], v[100:103], a[188:191]
    v_mfma_f32_16x16x32_bf16 a[176:179], a[128:131], v[104:107], a[176:179]
    s_add_u32 s21, s84, 0
    v_mfma_f32_16x16x32_bf16 a[180:183], a[132:135], v[104:107], a[180:183]
    buffer_load_dwordx4 v[160:163], v14, s[60:63], s21 offen sc1
    v_mfma_f32_16x16x32_bf16 a[184:187], a[136:139], v[104:107], a[184:187]
    v_mfma_f32_16x16x32_bf16 a[188:191], a[140:143], v[104:107], a[188:191]
    s_waitcnt lgkmcnt(8)
    v_mfma_f32_16x16x32_bf16 a[176:179], a[144:147], v[108:111], a[176:179]
    v_mfma_f32_16x16x32_bf16 a[180:183], a[148:151], v[108:111], a[180:183]
    buffer_load_dwordx4 v[164:167], v14, s[60:63], s21 offen offset:1024 sc1
    v_mfma_f32_16x16x32_bf16 a[184:187], a[152:155], v[108:111], a[184:187]
    v_mfma_f32_16x16x32_bf16 a[188:191], a[156:159], v[108:111], a[188:191]
    s_waitcnt lgkmcnt(0)
    v_mfma_f32_16x16x32_bf16 a[176:179], a[160:163], v[112:115], a[176:179]
    v_mfma_f32_16x16x32_bf16 a[180:183], a[164:167], v[112:115], a[180:183]
    v_mfma_f32_16x16x32_bf16 a[184:187], a[168:171], v[112:115], a[184:187]
    v_mfma_f32_16x16x32_bf16 a[188:191], a[172:175], v[112:115], a[188:191]
    s_waitcnt vmcnt(15)
    v_mfma_f32_16x16x32_bf16 a[192:195], a[0:3], v[116:119], 0
    v_mfma_f32_16x16x32_bf16 a[196:199], a[4:7], v[116:119], 0
    s_add_u32 s21, s84, 0
    v_mfma_f32_16x16x32_bf16 a[200:203], a[8:11], v[116:119], 0
    buffer_load_dwordx4 v[168:171], v14, s[60:63], s21 offen offset:2048 sc1
    v_mfma_f32_16x16x32_bf16 a[204:207], a[12:15], v[116:119], 0
    s_waitcnt vmcnt(15)
    v_mfma_f32_16x16x32_bf16 a[192:195], a[16:19], v[120:123], a[192:195]
    v_mfma_f32_16x16x32_bf16 a[196:199], a[20:23], v[120:123], a[196:199]
    v_mfma_f32_16x16x32_bf16 a[200:203], a[24:27], v[120:123], a[200:203]
    buffer_load_dwordx4 v[172:175], v14, s[60:63], s21 offen offset:3072 sc1
    s_waitcnt vmcnt(14)
    s_barrier
    s_cmp_lg_u32 s64, 0
    s_cbranch_scc1 PUB_22
    s_mov_b64 exec, 1
    v_mov_b32 v26, s98
    v_mov_b32 v27, s99
    s_lshl_b32 s86, s2, 7
    s_add_u32 s86, s86, 14745600
    buffer_store_dwordx2 v[26:27], off, s[48:51], s86 sc1
    s_mov_b64 exec, -1
PUB_22:
    v_mfma_f32_16x16x32_bf16 a[204:207], a[28:31], v[120:123], a[204:207]
    s_waitcnt vmcnt(13)
    v_mfma_f32_16x16x32_bf16 a[192:195], a[32:35], v[124:127], a[192:195]
    v_mfma_f32_16x16x32_bf16 a[196:199], a[36:39], v[124:127], a[196:199]
    s_add_u32 s74, s64, 1
    s_and_b32 s74, s74, 3
    s_mul_i32 s74, s74, 12288
    s_add_u32 s74, s74, 86016
    v_add_u32 v5, s74, v14
    ds_write_b128 v5, a[176:179] offset:0
    v_mfma_f32_16x16x32_bf16 a[200:203], a[40:43], v[124:127], a[200:203]
    s_add_u32 s21, s84, 4096
    ds_write_b128 v5, a[180:183] offset:1024
    v_mfma_f32_16x16x32_bf16 a[204:207], a[44:47], v[124:127], a[204:207]
    buffer_load_dwordx4 v[176:179], v14, s[60:63], s21 offen sc1
    ds_write_b128 v5, a[184:187] offset:2048
    s_waitcnt vmcnt(13)
    v_mfma_f32_16x16x32_bf16 a[192:195], a[48:51], v[128:131], a[192:195]
    ds_write_b128 v5, a[188:191] offset:3072
    v_mfma_f32_16x16x32_bf16 a[196:199], a[52:55], v[128:131], a[196:199]
    v_mfma_f32_16x16x32_bf16 a[200:203], a[56:59], v[128:131], a[200:203]
    v_mfma_f32_16x16x32_bf16 a[204:207], a[60:63], v[128:131], a[204:207]
    buffer_load_dwordx4 v[180:183], v14, s[60:63], s21 offen offset:1024 sc1
    s_waitcnt vmcnt(12)
    v_mfma_f32_16x16x32_bf16 a[192:195], a[64:67], v[132:135], a[192:195]
    v_mfma_f32_16x16x32_bf16 a[196:199], a[68:71], v[132:135], a[196:199]
    v_mfma_f32_16x16x32_bf16 a[200:203], a[72:75], v[132:135], a[200:203]
    v_mfma_f32_16x16x32_bf16 a[204:207], a[76:79], v[132:135], a[204:207]
    s_waitcnt vmcnt(11)
    v_mfma_f32_16x16x32_bf16 a[192:195], a[80:83], v[136:139], a[192:195]
    buffer_load_dwordx4 v[184:187], v14, s[60:63], s21 offen offset:2048 sc1
    v_mfma_f32_16x16x32_bf16 a[196:199], a[84:87], v[136:139], a[196:199]
    v_mfma_f32_16x16x32_bf16 a[200:203], a[88:91], v[136:139], a[200:203]
    v_mfma_f32_16x16x32_bf16 a[204:207], a[92:95], v[136:139], a[204:207]
    s_waitcnt vmcnt(11)
    v_mfma_f32_16x16x32_bf16 a[192:195], a[96:99], v[140:143], a[192:195]
    buffer_load_dwordx4 v[188:191], v14, s[60:63], s21 offen offset:3072 sc1
    v_mfma_f32_16x16x32_bf16 a[196:199], a[100:103], v[140:143], a[196:199]
    v_mfma_f32_16x16x32_bf16 a[200:203], a[104:107], v[140:143], a[200:203]
    v_mfma_f32_16x16x32_bf16 a[204:207], a[108:111], v[140:143], a[204:207]
    s_add_u32 s21, s84, 8192
    s_waitcnt vmcnt(11)
    v_mfma_f32_16x16x32_bf16 a[192:195], a[112:115], v[144:147], a[192:195]
    buffer_load_dwordx4 v[192:195], v14, s[60:63], s21 offen sc1
    v_mfma_f32_16x16x32_bf16 a[196:199], a[116:119], v[144:147], a[196:199]
    v_mfma_f32_16x16x32_bf16 a[200:203], a[120:123], v[144:147], a[200:203]
    v_mfma_f32_16x16x32_bf16 a[204:207], a[124:127], v[144:147], a[204:207]
    s_waitcnt vmcnt(11)
    v_mfma_f32_16x16x32_bf16 a[192:195], a[128:131], v[148:151], a[192:195]
    v_mfma_f32_16x16x32_bf16 a[196:199], a[132:135], v[148:151], a[196:199]
    buffer_load_dwordx4 v[196:199], v14, s[60:63], s21 offen offset:1024 sc1
    v_mfma_f32_16x16x32_bf16 a[200:203], a[136:139], v[148:151], a[200:203]
    v_mfma_f32_16x16x32_bf16 a[204:207], a[140:143], v[148:151], a[204:207]
    s_waitcnt vmcnt(11)
    v_mfma_f32_16x16x32_bf16 a[192:195], a[144:147], v[152:155], a[192:195]
    v_mfma_f32_16x16x32_bf16 a[196:199], a[148:151], v[152:155], a[196:199]
    buffer_load_dwordx4 v[200:203], v25, s[60:63], s21 offen offset:2048 sc1
    v_mfma_f32_16x16x32_bf16 a[200:203], a[152:155], v[152:155], a[200:203]
    v_mfma_f32_16x16x32_bf16 a[204:207], a[156:159], v[152:155], a[204:207]
    s_waitcnt vmcnt(11)
    v_mfma_f32_16x16x32_bf16 a[192:195], a[160:163], v[156:159], a[192:195]
    v_mfma_f32_16x16x32_bf16 a[196:199], a[164:167], v[156:159], a[196:199]
    v_mfma_f32_16x16x32_bf16 a[200:203], a[168:171], v[156:159], a[200:203]
    v_mfma_f32_16x16x32_bf16 a[204:207], a[172:175], v[156:159], a[204:207]
    s_waitcnt vmcnt(10)
    v_mfma_f32_16x16x32_bf16 a[208:211], a[0:3], v[160:163], 0
    s_add_u32 s21, s85, 0
    v_mfma_f32_16x16x32_bf16 a[212:215], a[4:7], v[160:163], 0
    buffer_load_dwordx4 v[204:207], v14, s[60:63], s21 offen sc1
    v_mfma_f32_16x16x32_bf16 a[216:219], a[8:11], v[160:163], 0
    buffer_load_dwordx2 v[26:27], v13, s[48:51], 0 offen sc1
    v_mfma_f32_16x16x32_bf16 a[220:223], a[12:15], v[160:163], 0
    s_waitcnt vmcnt(11)
    v_mfma_f32_16x16x32_bf16 a[208:211], a[16:19], v[164:167], a[208:211]
    v_mfma_f32_16x16x32_bf16 a[212:215], a[20:23], v[164:167], a[212:215]
    buffer_load_dwordx4 v[208:211], v14, s[60:63], s21 offen offset:1024 sc1
    v_mfma_f32_16x16x32_bf16 a[216:219], a[24:27], v[164:167], a[216:219]
    v_mfma_f32_16x16x32_bf16 a[220:223], a[28:31], v[164:167], a[220:223]
    s_waitcnt vmcnt(11)
    v_mfma_f32_16x16x32_bf16 a[208:211], a[32:35], v[168:171], a[208:211]
    v_mfma_f32_16x16x32_bf16 a[212:215], a[36:39], v[168:171], a[212:215]
    buffer_load_dwordx4 v[212:215], v14, s[60:63], s21 offen offset:2048 sc1
    s_add_u32 s74, s64, 2
    s_and_b32 s74, s74, 3
    s_mul_i32 s74, s74, 12288
    s_add_u32 s74, s74, 90112
    v_add_u32 v5, s74, v14
    v_mfma_f32_16x16x32_bf16 a[216:219], a[40:43], v[168:171], a[216:219]
    ds_write_b128 v5, a[192:195] offset:0
    ds_write_b128 v5, a[196:199] offset:1024
    v_mfma_f32_16x16x32_bf16 a[220:223], a[44:47], v[168:171], a[220:223]
    ds_write_b128 v5, a[200:203] offset:2048
    ds_write_b128 v5, a[204:207] offset:3072
    s_waitcnt vmcnt(11)
    v_mfma_f32_16x16x32_bf16 a[208:211], a[48:51], v[172:175], a[208:211]
    buffer_load_dwordx4 v[216:219], v14, s[60:63], s21 offen offset:3072 sc1
    v_mfma_f32_16x16x32_bf16 a[212:215], a[52:55], v[172:175], a[212:215]
    v_mfma_f32_16x16x32_bf16 a[216:219], a[56:59], v[172:175], a[216:219]
    v_mfma_f32_16x16x32_bf16 a[220:223], a[60:63], v[172:175], a[220:223]
    s_add_u32 s21, s85, 4096
    s_waitcnt vmcnt(11)
    v_mfma_f32_16x16x32_bf16 a[208:211], a[64:67], v[176:179], a[208:211]
    buffer_load_dwordx4 v[220:223], v14, s[60:63], s21 offen sc1
    v_mfma_f32_16x16x32_bf16 a[212:215], a[68:71], v[176:179], a[212:215]
    v_mfma_f32_16x16x32_bf16 a[216:219], a[72:75], v[176:179], a[216:219]
    v_mfma_f32_16x16x32_bf16 a[220:223], a[76:79], v[176:179], a[220:223]
    s_waitcnt vmcnt(11)
    v_mfma_f32_16x16x32_bf16 a[208:211], a[80:83], v[180:183], a[208:211]
    buffer_load_dwordx4 v[224:227], v14, s[60:63], s21 offen offset:1024 sc1
    v_mfma_f32_16x16x32_bf16 a[212:215], a[84:87], v[180:183], a[212:215]
    v_mfma_f32_16x16x32_bf16 a[216:219], a[88:91], v[180:183], a[216:219]
    v_mfma_f32_16x16x32_bf16 a[220:223], a[92:95], v[180:183], a[220:223]
    buffer_load_dwordx4 v[228:231], v14, s[60:63], s21 offen offset:2048 sc1
    s_waitcnt vmcnt(12)
    v_mfma_f32_16x16x32_bf16 a[208:211], a[96:99], v[184:187], a[208:211]
    v_mfma_f32_16x16x32_bf16 a[212:215], a[100:103], v[184:187], a[212:215]
    v_mfma_f32_16x16x32_bf16 a[216:219], a[104:107], v[184:187], a[216:219]
    v_mfma_f32_16x16x32_bf16 a[220:223], a[108:111], v[184:187], a[220:223]
    buffer_load_dwordx4 v[232:235], v14, s[60:63], s21 offen offset:3072 sc1
    s_waitcnt vmcnt(12)
    v_mfma_f32_16x16x32_bf16 a[208:211], a[112:115], v[188:191], a[208:211]
    v_mfma_f32_16x16x32_bf16 a[212:215], a[116:119], v[188:191], a[212:215]
    s_add_u32 s21, s85, 8192
    v_mfma_f32_16x16x32_bf16 a[216:219], a[120:123], v[188:191], a[216:219]
    buffer_load_dwordx4 v[236:239], v14, s[60:63], s21 offen sc1
    v_mfma_f32_16x16x32_bf16 a[220:223], a[124:127], v[188:191], a[220:223]
    s_waitcnt vmcnt(12)
    v_mfma_f32_16x16x32_bf16 a[208:211], a[128:131], v[192:195], a[208:211]
    v_mfma_f32_16x16x32_bf16 a[212:215], a[132:135], v[192:195], a[212:215]
    v_mfma_f32_16x16x32_bf16 a[216:219], a[136:139], v[192:195], a[216:219]
    buffer_load_dwordx4 v[240:243], v14, s[60:63], s21 offen offset:1024 sc1
    v_mfma_f32_16x16x32_bf16 a[220:223], a[140:143], v[192:195], a[220:223]
    s_waitcnt vmcnt(12)
    v_mfma_f32_16x16x32_bf16 a[208:211], a[144:147], v[196:199], a[208:211]
    v_mfma_f32_16x16x32_bf16 a[212:215], a[148:151], v[196:199], a[212:215]
    v_mfma_f32_16x16x32_bf16 a[216:219], a[152:155], v[196:199], a[216:219]
    buffer_load_dwordx4 v[244:247], v25, s[60:63], s21 offen offset:2048 sc1
    v_mfma_f32_16x16x32_bf16 a[220:223], a[156:159], v[196:199], a[220:223]
    s_waitcnt vmcnt(12)
    v_mfma_f32_16x16x32_bf16 a[208:211], a[160:163], v[200:203], a[208:211]
    v_mfma_f32_16x16x32_bf16 a[212:215], a[164:167], v[200:203], a[212:215]
    v_mfma_f32_16x16x32_bf16 a[216:219], a[168:171], v[200:203], a[216:219]
    v_mfma_f32_16x16x32_bf16 a[220:223], a[172:175], v[200:203], a[220:223]
    s_waitcnt vmcnt(11)
    v_mfma_f32_16x16x32_bf16 v[40:43], a[0:3], v[204:207], 0
    v_mfma_f32_16x16x32_bf16 v[44:47], a[4:7], v[204:207], 0
    v_mfma_f32_16x16x32_bf16 v[48:51], a[8:11], v[204:207], 0
    v_mfma_f32_16x16x32_bf16 v[52:55], a[12:15], v[204:207], 0
    s_waitcnt vmcnt(9)
    v_mfma_f32_16x16x32_bf16 v[40:43], a[16:19], v[208:211], v[40:43]
    v_cmp_ne_u64 vcc, s[98:99], v[26:27]
    s_cbranch_vccz POLLD_24
    s_mov_b32 s86, 4000
POLL_23:
    s_sleep 2
    buffer_load_dwordx2 v[26:27], v13, s[48:51], 0 offen sc1
    s_waitcnt vmcnt(0)
    v_cmp_ne_u64 vcc, s[98:99], v[26:27]
    s_cbranch_vccz POLLD_24
    s_sub_u32 s86, s86, 1
    s_cmp_lg_u32 s86, 0
    s_cbranch_scc1 POLL_23
POLLD_24:
    s_lshl_b32 s74, s73, 6
    s_lshl_b32 s75, s64, 4
    s_add_u32 s74, s74, s75
    s_lshl_b32 s74, s74, 12
    s_lshl_b32 s75, s72, 7
    s_add_u32 s74, s74, s75
    s_add_u32 s74, s74, 10485760
    s_lshl_b32 s76, s64, 11
    s_add_u32 s76, s76, 151552
    s_add_u32 m0, s76, 0
    s_add_u32 s75, s74, 0
    buffer_load_dwordx4 v28, s[48:51], s75 offen sc1 lds
    s_add_u32 m0, s76, 1024
    s_add_u32 s75, s74, 32768
    buffer_load_dwordx4 v28, s[48:51], s75 offen sc1 lds
    v_mfma_f32_16x16x32_bf16 v[44:47], a[20:23], v[208:211], v[44:47]
    v_mfma_f32_16x16x32_bf16 v[48:51], a[24:27], v[208:211], v[48:51]
    v_mfma_f32_16x16x32_bf16 v[52:55], a[28:31], v[208:211], v[52:55]
    s_waitcnt vmcnt(10)
    v_mfma_f32_16x16x32_bf16 v[40:43], a[32:35], v[212:215], v[40:43]
    v_mfma_f32_16x16x32_bf16 v[44:47], a[36:39], v[212:215], v[44:47]
    s_add_u32 s74, s64, 3
    s_and_b32 s74, s74, 3
    s_mul_i32 s74, s74, 12288
    s_add_u32 s74, s74, 94208
    v_add_u32 v5, s74, v14
    ds_write_b128 v5, a[208:211] offset:0
    v_mfma_f32_16x16x32_bf16 v[48:51], a[40:43], v[212:215], v[48:51]
    ds_write_b128 v5, a[212:215] offset:1024
    ds_write_b128 v5, a[216:219] offset:2048
    v_mfma_f32_16x16x32_bf16 v[52:55], a[44:47], v[212:215], v[52:55]
    ds_write_b128 v5, a[220:223] offset:3072
    s_waitcnt vmcnt(9)
    v_mfma_f32_16x16x32_bf16 v[40:43], a[48:51], v[216:219], v[40:43]
    v_mfma_f32_16x16x32_bf16 v[44:47], a[52:55], v[216:219], v[44:47]
    v_mfma_f32_16x16x32_bf16 v[48:51], a[56:59], v[216:219], v[48:51]
    v_mfma_f32_16x16x32_bf16 v[52:55], a[60:63], v[216:219], v[52:55]
    s_waitcnt vmcnt(8)
    v_mfma_f32_16x16x32_bf16 v[40:43], a[64:67], v[220:223], v[40:43]
    v_mfma_f32_16x16x32_bf16 v[44:47], a[68:71], v[220:223], v[44:47]
    v_mfma_f32_16x16x32_bf16 v[48:51], a[72:75], v[220:223], v[48:51]
    v_mfma_f32_16x16x32_bf16 v[52:55], a[76:79], v[220:223], v[52:55]
    s_waitcnt vmcnt(7)
    v_mfma_f32_16x16x32_bf16 v[40:43], a[80:83], v[224:227], v[40:43]
    v_mfma_f32_16x16x32_bf16 v[44:47], a[84:87], v[224:227], v[44:47]
    v_mfma_f32_16x16x32_bf16 v[48:51], a[88:91], v[224:227], v[48:51]
    v_mfma_f32_16x16x32_bf16 v[52:55], a[92:95], v[224:227], v[52:55]
    s_waitcnt vmcnt(6)
    v_mfma_f32_16x16x32_bf16 v[40:43], a[96:99], v[228:231], v[40:43]
    v_mfma_f32_16x16x32_bf16 v[44:47], a[100:103], v[228:231], v[44:47]
    v_mfma_f32_16x16x32_bf16 v[48:51], a[104:107], v[228:231], v[48:51]
    v_mfma_f32_16x16x32_bf16 v[52:55], a[108:111], v[228:231], v[52:55]
    s_waitcnt vmcnt(5)
    v_mfma_f32_16x16x32_bf16 v[40:43], a[112:115], v[232:235], v[40:43]
    v_mfma_f32_16x16x32_bf16 v[44:47], a[116:119], v[232:235], v[44:47]
    v_mfma_f32_16x16x32_bf16 v[48:51], a[120:123], v[232:235], v[48:51]
    v_mfma_f32_16x16x32_bf16 v[52:55], a[124:127], v[232:235], v[52:55]
    s_waitcnt vmcnt(4)
    v_mfma_f32_16x16x32_bf16 v[40:43], a[128:131], v[236:239], v[40:43]
    v_mfma_f32_16x16x32_bf16 v[44:47], a[132:135], v[236:239], v[44:47]
    v_mfma_f32_16x16x32_bf16 v[48:51], a[136:139], v[236:239], v[48:51]
    v_mfma_f32_16x16x32_bf16 v[52:55], a[140:143], v[236:239], v[52:55]
    s_waitcnt vmcnt(3)
    v_mfma_f32_16x16x32_bf16 v[40:43], a[144:147], v[240:243], v[40:43]
    v_mfma_f32_16x16x32_bf16 v[44:47], a[148:151], v[240:243], v[44:47]
    v_mfma_f32_16x16x32_bf16 v[48:51], a[152:155], v[240:243], v[48:51]
    v_mfma_f32_16x16x32_bf16 v[52:55], a[156:159], v[240:243], v[52:55]
    s_waitcnt vmcnt(2)
    v_mfma_f32_16x16x32_bf16 v[40:43], a[160:163], v[244:247], v[40:43]
    v_mfma_f32_16x16x32_bf16 v[44:47], a[164:167], v[244:247], v[44:47]
    v_mfma_f32_16x16x32_bf16 v[48:51], a[168:171], v[244:247], v[48:51]
    v_mfma_f32_16x16x32_bf16 v[52:55], a[172:175], v[244:247], v[52:55]
    s_waitcnt vmcnt(0)
    s_waitcnt lgkmcnt(0)
    s_barrier
    s_mul_i32 s74, s64, 12288
    s_add_u32 s74, s74, 86016
    v_add_u32 v5, s74, v14
    ds_read_b128 v[72:75], v5 offset:0
    ds_read_b128 v[76:79], v5 offset:1024
    ds_read_b128 v[80:83], v5 offset:2048
    ds_read_b128 v[84:87], v5 offset:3072
    ds_read_b128 v[88:91], v5 offset:4096
    ds_read_b128 v[92:95], v5 offset:5120
    ds_read_b128 v[96:99], v5 offset:6144
    ds_read_b128 v[100:103], v5 offset:7168
    ds_read_b128 v[104:107], v5 offset:8192
    ds_read_b128 v[108:111], v5 offset:9216
    ds_read_b128 v[112:115], v5 offset:10240
    ds_read_b128 v[116:119], v5 offset:11264
    ds_read_b64_tr_b16 v[120:121], v29 offset:0
    ds_read_b64_tr_b16 v[122:123], v29 offset:2048
    ds_read_b64_tr_b16 v[124:125], v29 offset:4096
    ds_read_b64_tr_b16 v[126:127], v29 offset:6144
    s_mov_b32 s92, 0xffff0000
    v_sub_f32 v4, 1.0, v3
    v_cvt_pk_bf16_f32 v4, v4, v4
    v_lshlrev_b32 v4, 16, v4
    v_mov_b32 v6, v3
    v_mov_b32 v7, v3
    v_mov_b32 v8, v4
    v_mov_b32 v9, v4
    s_waitcnt lgkmcnt(12)
    v_pk_add_f32 v[40:41], v[40:41], v[72:73]
    v_pk_add_f32 v[42:43], v[42:43], v[74:75]
    v_pk_add_f32 v[44:45], v[44:45], v[76:77]
    v_pk_add_f32 v[46:47], v[46:47], v[78:79]
    v_pk_add_f32 v[48:49], v[48:49], v[80:81]
    v_pk_add_f32 v[50:51], v[50:51], v[82:83]
    v_pk_add_f32 v[52:53], v[52:53], v[84:85]
    v_pk_add_f32 v[54:55], v[54:55], v[86:87]
    s_waitcnt lgkmcnt(8)
    v_pk_add_f32 v[40:41], v[40:41], v[88:89]
    v_pk_add_f32 v[42:43], v[42:43], v[90:91]
    v_pk_add_f32 v[44:45], v[44:45], v[92:93]
    v_pk_add_f32 v[46:47], v[46:47], v[94:95]
    v_pk_add_f32 v[48:49], v[48:49], v[96:97]
    v_pk_add_f32 v[50:51], v[50:51], v[98:99]
    v_pk_add_f32 v[52:53], v[52:53], v[100:101]
    v_pk_add_f32 v[54:55], v[54:55], v[102:103]
    s_waitcnt lgkmcnt(4)
    v_pk_add_f32 v[40:41], v[40:41], v[104:105]
    v_pk_add_f32 v[42:43], v[42:43], v[106:107]
    v_pk_add_f32 v[44:45], v[44:45], v[108:109]
    v_pk_add_f32 v[46:47], v[46:47], v[110:111]
    v_pk_add_f32 v[48:49], v[48:49], v[112:113]
    v_pk_add_f32 v[50:51], v[50:51], v[114:115]
    v_pk_add_f32 v[52:53], v[52:53], v[116:117]
    v_pk_add_f32 v[54:55], v[54:55], v[118:119]
    s_waitcnt lgkmcnt(0)
    v_lshlrev_b32 v128, 16, v120
    v_and_b32 v129, s92, v120
    v_lshlrev_b32 v130, 16, v121
    v_and_b32 v131, s92, v121
    v_pk_mul_f32 v[40:41], v[40:41], v[8:9]
    v_pk_mul_f32 v[42:43], v[42:43], v[8:9]
    v_pk_fma_f32 v[40:41], v[128:129], v[6:7], v[40:41]
    v_pk_fma_f32 v[42:43], v[130:131], v[6:7], v[42:43]
    v_cvt_pk_bf16_f32 v128, v40, v41
    v_cvt_pk_bf16_f32 v129, v42, v43
    v_lshlrev_b32 v132, 16, v122
    v_and_b32 v133, s92, v122
    v_lshlrev_b32 v134, 16, v123
    v_and_b32 v135, s92, v123
    v_pk_mul_f32 v[44:45], v[44:45], v[8:9]
    v_pk_mul_f32 v[46:47], v[46:47], v[8:9]
    v_pk_fma_f32 v[44:45], v[132:133], v[6:7], v[44:45]
    v_pk_fma_f32 v[46:47], v[134:135], v[6:7], v[46:47]
    v_cvt_pk_bf16_f32 v132, v44, v45
    v_cvt_pk_bf16_f32 v133, v46, v47
    v_lshlrev_b32 v136, 16, v124
    v_and_b32 v137, s92, v124
    v_lshlrev_b32 v138, 16, v125
    v_and_b32 v139, s92, v125
    v_pk_mul_f32 v[48:49], v[48:49], v[8:9]
    v_pk_mul_f32 v[50:51], v[50:51], v[8:9]
    v_pk_fma_f32 v[48:49], v[136:137], v[6:7], v[48:49]
    v_pk_fma_f32 v[50:51], v[138:139], v[6:7], v[50:51]
    v_cvt_pk_bf16_f32 v136, v48, v49
    v_cvt_pk_bf16_f32 v137, v50, v51
    v_lshlrev_b32 v140, 16, v126
    v_and_b32 v141, s92, v126
    v_lshlrev_b32 v142, 16, v127
    v_and_b32 v143, s92, v127
    v_pk_mul_f32 v[52:53], v[52:53], v[8:9]
    v_pk_mul_f32 v[54:55], v[54:55], v[8:9]
    v_pk_fma_f32 v[52:53], v[140:141], v[6:7], v[52:53]
    v_pk_fma_f32 v[54:55], v[142:143], v[6:7], v[54:55]
    v_cvt_pk_bf16_f32 v140, v52, v53
    v_cvt_pk_bf16_f32 v141, v54, v55
    s_mul_i32 s74, s64, 20480
    v_and_b32 v10, 15, v1
    v_lshrrev_b32 v11, 4, v1
    v_mul_u32_u24 v10, 144, v10
    v_lshl_add_u32 v10, v11, 3, v10
    v_add_u32 v10, s74, v10
    v_lshrrev_b32 v11, 3, v1
    v_and_b32 v12, 7, v1
    v_mul_u32_u24 v13, 144, v11
    v_lshl_add_u32 v13, v12, 4, v13
    v_add_u32 v13, s74, v13
    v_lshlrev_b32 v11, 10, v11
    v_lshl_add_u32 v11, v12, 4, v11
    s_lshl_b32 s74, s72, 6
    s_lshl_b32 s75, s64, 4
    s_add_u32 s74, s74, s75
    s_lshl_b32 s74, s74, 10
    s_lshl_b32 s75, s73, 7
    s_add_u32 s74, s74, s75
    ds_write_b64 v10, v[128:129] offset:0
    ds_write_b64 v10, v[132:133] offset:32
    ds_write_b64 v10, v[136:137] offset:64
    ds_write_b64 v10, v[140:141] offset:96
    s_waitcnt lgkmcnt(0)
    ds_read_b128 v[16:19], v13 offset:0
    ds_read_b128 v[20:23], v13 offset:1152
    s_waitcnt lgkmcnt(1)
    s_add_u32 s75, s74, 0
    buffer_store_dwordx4 v[16:19], v11, s[52:55], s75 offen sc1
    s_waitcnt lgkmcnt(0)
    s_add_u32 s75, s74, 8192
    buffer_store_dwordx4 v[20:23], v11, s[52:55], s75 offen sc1
END:
    s_endpgm
GATE_9:
    v_add_u32 v144, 86016, v7
    v_add_u32 v145, 86016, v8
    v_lshrrev_b32 v212, 4, v1
    v_lshlrev_b32 v212, 4, v212
    s_add_u32 s74, s19, 0
    s_and_b32 s74, s74, 7
    s_lshl_b32 s74, s74, 7
    v_add_u32 v213, s74, v212
    global_load_dwordx4 v[148:151], v213, s[28:29] offset:0
    global_load_dwordx4 v[152:155], v213, s[28:29] offset:64
    s_add_u32 s74, s19, 1
    s_and_b32 s74, s74, 7
    s_lshl_b32 s74, s74, 7
    v_add_u32 v213, s74, v212
    global_load_dwordx4 v[156:159], v213, s[28:29] offset:0
    global_load_dwordx4 v[160:163], v213, s[28:29] offset:64
    s_add_u32 s74, s19, 2
    s_and_b32 s74, s74, 7
    s_lshl_b32 s74, s74, 7
    v_add_u32 v213, s74, v212
    global_load_dwordx4 v[164:167], v213, s[28:29] offset:0
    global_load_dwordx4 v[168:171], v213, s[28:29] offset:64
    s_add_u32 s74, s19, 3
    s_and_b32 s74, s74, 7
    s_lshl_b32 s74, s74, 7
    v_add_u32 v213, s74, v212
    global_load_dwordx4 v[172:175], v213, s[28:29] offset:0
    global_load_dwordx4 v[176:179], v213, s[28:29] offset:64
    s_add_u32 s74, s19, 4
    s_and_b32 s74, s74, 7
    s_lshl_b32 s74, s74, 7
    v_add_u32 v213, s74, v212
    global_load_dwordx4 v[180:183], v213, s[28:29] offset:0
    global_load_dwordx4 v[184:187], v213, s[28:29] offset:64
    s_add_u32 s74, s19, 5
    s_and_b32 s74, s74, 7
    s_lshl_b32 s74, s74, 7
    v_add_u32 v213, s74, v212
    global_load_dwordx4 v[188:191], v213, s[28:29] offset:0
    global_load_dwordx4 v[192:195], v213, s[28:29] offset:64
    s_add_u32 s74, s19, 6
    s_and_b32 s74, s74, 7
    s_lshl_b32 s74, s74, 7
    v_add_u32 v213, s74, v212
    global_load_dwordx4 v[196:199], v213, s[28:29] offset:0
    global_load_dwordx4 v[200:203], v213, s[28:29] offset:64
    s_add_u32 s74, s19, 7
    s_and_b32 s74, s74, 7
    s_lshl_b32 s74, s74, 7
    v_add_u32 v213, s74, v212
    global_load_dwordx4 v[204:207], v213, s[28:29] offset:0
    global_load_dwordx4 v[208:211], v213, s[28:29] offset:64
    ds_read_b128 v[80:83], v7 offset:0
    ds_read_b128 v[84:87], v7 offset:2048
    s_waitcnt vmcnt(0)
    s_waitcnt lgkmcnt(1)
    v_mfma_f32_16x16x32_bf16 v[32:35], v[148:151], v[80:83], 0
    s_add_u32 m0, s23, 114688
    s_add_u32 s18, s19, 4
    s_and_b32 s18, s18, 7
    s_lshl_b32 s22, s18, 7
    s_add_u32 s22, s22, s80
    s_waitcnt lgkmcnt(0)
    v_mfma_f32_16x16x32_bf16 v[36:39], v[148:151], v[84:87], 0
    buffer_load_dwordx4 v2, s[36:39], s22 offen lds
    ds_read_b128 v[112:115], v8 offset:0
    ds_read_b128 v[116:119], v8 offset:2048
    s_waitcnt lgkmcnt(0)
    s_barrier
    s_cmp_lg_u32 s64, 0
    s_cbranch_scc1 ZA_14
    v_lshlrev_b32 v26, 3, v1
    v_add_u32 v26, 160768, v26
    v_mov_b32 v214, 0
    v_mov_b32 v215, 0
    ds_write_b64 v26, v[214:215]
    s_waitcnt lgkmcnt(0)
ZA_14:
    v_mfma_f32_16x16x32_bf16 v[32:35], v[152:155], v[112:115], v[32:35]
    buffer_load_dwordx4 v3, s[36:39], s22 offen offset:1024 lds
    ds_read_b128 v[80:83], v7 offset:16384
    v_mfma_f32_16x16x32_bf16 v[36:39], v[152:155], v[116:119], v[36:39]
    buffer_load_dwordx4 v30, s[36:39], s22 offen offset:2048 lds
    buffer_load_dwordx4 v25, s[36:39], s22 offen offset:3072 lds
    ds_read_b128 v[84:87], v7 offset:18432
    s_waitcnt lgkmcnt(1)
    v_mfma_f32_16x16x32_bf16 v[32:35], v[156:159], v[80:83], v[32:35]
    s_add_u32 m0, s23, 0
    s_add_u32 s18, s19, 5
    s_and_b32 s18, s18, 7
    s_lshl_b32 s22, s18, 7
    s_add_u32 s22, s22, s80
    s_waitcnt lgkmcnt(0)
    v_mfma_f32_16x16x32_bf16 v[36:39], v[156:159], v[84:87], v[36:39]
    buffer_load_dwordx4 v2, s[36:39], s22 offen lds
    ds_read_b128 v[112:115], v8 offset:16384
    ds_read_b128 v[116:119], v8 offset:18432
    s_waitcnt lgkmcnt(0)
    s_barrier
    v_mfma_f32_16x16x32_bf16 v[32:35], v[160:163], v[112:115], v[32:35]
    buffer_load_dwordx4 v3, s[36:39], s22 offen offset:1024 lds
    ds_read_b128 v[80:83], v7 offset:32768
    v_mfma_f32_16x16x32_bf16 v[36:39], v[160:163], v[116:119], v[36:39]
    buffer_load_dwordx4 v30, s[36:39], s22 offen offset:2048 lds
    buffer_load_dwordx4 v25, s[36:39], s22 offen offset:3072 lds
    ds_read_b128 v[84:87], v7 offset:34816
    s_waitcnt lgkmcnt(1)
    v_mfma_f32_16x16x32_bf16 v[32:35], v[164:167], v[80:83], v[32:35]
    s_add_u32 m0, s23, 16384
    s_add_u32 s18, s19, 6
    s_and_b32 s18, s18, 7
    s_lshl_b32 s22, s18, 7
    s_add_u32 s22, s22, s80
    s_waitcnt lgkmcnt(0)
    v_mfma_f32_16x16x32_bf16 v[36:39], v[164:167], v[84:87], v[36:39]
    buffer_load_dwordx4 v2, s[36:39], s22 offen lds
    ds_read_b128 v[112:115], v8 offset:32768
    ds_read_b128 v[116:119], v8 offset:34816
    s_waitcnt lgkmcnt(0)
    s_barrier
    buffer_load_dwordx2 v[26:27], v11, s[48:51], 0 offen sc1
    v_mfma_f32_16x16x32_bf16 v[32:35], v[168:171], v[112:115], v[32:35]
    buffer_load_dwordx4 v3, s[36:39], s22 offen offset:1024 lds
    ds_read_b128 v[80:83], v144 offset:0
    v_mfma_f32_16x16x32_bf16 v[36:39], v[168:171], v[116:119], v[36:39]
    buffer_load_dwordx4 v30, s[36:39], s22 offen offset:2048 lds
    buffer_load_dwordx4 v25, s[36:39], s22 offen offset:3072 lds
    ds_read_b128 v[84:87], v144 offset:2048
    s_waitcnt lgkmcnt(1)
    v_mfma_f32_16x16x32_bf16 v[32:35], v[172:175], v[80:83], v[32:35]
    s_add_u32 m0, s23, 32768
    s_add_u32 s18, s19, 7
    s_and_b32 s18, s18, 7
    s_lshl_b32 s22, s18, 7
    s_add_u32 s22, s22, s80
    s_waitcnt lgkmcnt(0)
    v_mfma_f32_16x16x32_bf16 v[36:39], v[172:175], v[84:87], v[36:39]
    buffer_load_dwordx4 v2, s[36:39], s22 offen lds
    ds_read_b128 v[112:115], v145 offset:0
    ds_read_b128 v[116:119], v145 offset:2048
    s_waitcnt lgkmcnt(0)
    s_waitcnt vmcnt(10)
    s_barrier
    v_mfma_f32_16x16x32_bf16 v[32:35], v[176:179], v[112:115], v[32:35]
    buffer_load_dwordx4 v3, s[36:39], s22 offen offset:1024 lds
    ds_read_b128 v[80:83], v144 offset:28672
    v_mfma_f32_16x16x32_bf16 v[36:39], v[176:179], v[116:119], v[36:39]
    buffer_load_dwordx4 v30, s[36:39], s22 offen offset:2048 lds
    buffer_load_dwordx4 v25, s[36:39], s22 offen offset:3072 lds
    ds_read_b128 v[84:87], v144 offset:30720
    s_waitcnt lgkmcnt(1)
    v_mfma_f32_16x16x32_bf16 v[32:35], v[180:183], v[80:83], v[32:35]
    ds_read_b128 v[112:115], v145 offset:28672
    ds_read_b128 v[116:119], v145 offset:30720
    s_waitcnt lgkmcnt(2)
    v_mfma_f32_16x16x32_bf16 v[36:39], v[180:183], v[84:87], v[36:39]
    s_waitcnt vmcnt(7)
    v_cmp_ne_u64 vcc, s[98:99], v[26:27]
    s_cbranch_vccz POLLD_16
    s_mov_b32 s86, 4000
POLL_15:
    s_sleep 2
    buffer_load_dwordx2 v[26:27], v11, s[48:51], 0 offen sc1
    s_waitcnt vmcnt(0)
    v_cmp_ne_u64 vcc, s[98:99], v[26:27]
    s_cbranch_vccz POLLD_16
    s_sub_u32 s86, s86, 1
    s_cmp_lg_u32 s86, 0
    s_cbranch_scc1 POLL_15
POLLD_16:
    s_lshr_b32 s74, s64, 1
    s_and_b32 s75, s64, 1
    s_add_u32 s76, s74, s71
    s_mul_i32 s76, s76, 4224
    s_add_u32 s76, s76, 128
    s_mul_i32 s77, s74, 33024
    s_mul_i32 s75, s75, 16512
    s_add_u32 s77, s77, s75
    s_add_u32 s77, s77, 86016
    s_and_b32 s75, s64, 1
    s_lshl_b32 s75, s75, 3
    s_add_u32 s76, s76, s75
    s_waitcnt lgkmcnt(0)
    s_barrier
    v_mfma_f32_16x16x32_bf16 v[32:35], v[184:187], v[112:115], v[32:35]
    s_add_u32 m0, s77, 0
    s_add_u32 s22, s76, 2228212
    buffer_load_dwordx4 v14, s[48:51], s22 offen sc1 lds
    v_mfma_f32_16x16x32_bf16 v[36:39], v[184:187], v[116:119], v[36:39]
    buffer_load_dwordx4 v14, s[48:51], s22 offen offset:1024 sc1 lds
    buffer_load_dwordx4 v14, s[48:51], s22 offen offset:2048 sc1 lds
    ds_read_b128 v[80:83], v7 offset:0
    ds_read_b128 v[84:87], v7 offset:2048
    s_waitcnt lgkmcnt(1)
    v_mfma_f32_16x16x32_bf16 v[32:35], v[188:191], v[80:83], v[32:35]
    buffer_load_dwordx4 v14, s[48:51], s22 offen offset:3072 sc1 lds
    s_add_u32 m0, s77, 4128
    s_sub_u32 s22, s76, 12
    s_waitcnt lgkmcnt(0)
    v_mfma_f32_16x16x32_bf16 v[36:39], v[188:191], v[84:87], v[36:39]
    buffer_load_dwordx4 v14, s[48:51], s22 offen sc1 lds
    ds_read_b128 v[112:115], v8 offset:0
    ds_read_b128 v[116:119], v8 offset:2048
    s_waitcnt lgkmcnt(0)
    s_waitcnt vmcnt(9)
    s_barrier
    v_mfma_f32_16x16x32_bf16 v[32:35], v[192:195], v[112:115], v[32:35]
    buffer_load_dwordx4 v14, s[48:51], s22 offen offset:1024 sc1 lds
    ds_read_b128 v[80:83], v7 offset:16384
    v_mfma_f32_16x16x32_bf16 v[36:39], v[192:195], v[116:119], v[36:39]
    buffer_load_dwordx4 v14, s[48:51], s22 offen offset:2048 sc1 lds
    buffer_load_dwordx4 v14, s[48:51], s22 offen offset:3072 sc1 lds
    s_add_u32 m0, s77, 8256
    ds_read_b128 v[84:87], v7 offset:18432
    s_waitcnt lgkmcnt(1)
    v_mfma_f32_16x16x32_bf16 v[32:35], v[196:199], v[80:83], v[32:35]
    s_add_u32 s22, s76, 2228216
    buffer_load_dwordx4 v14, s[48:51], s22 offen sc1 lds
    s_waitcnt lgkmcnt(0)
    v_mfma_f32_16x16x32_bf16 v[36:39], v[196:199], v[84:87], v[36:39]
    buffer_load_dwordx4 v14, s[48:51], s22 offen offset:1024 sc1 lds
    buffer_load_dwordx4 v14, s[48:51], s22 offen offset:2048 sc1 lds
    ds_read_b128 v[112:115], v8 offset:16384
    ds_read_b128 v[116:119], v8 offset:18432
    s_waitcnt lgkmcnt(0)
    s_waitcnt vmcnt(11)
    s_barrier
    v_mfma_f32_16x16x32_bf16 v[32:35], v[200:203], v[112:115], v[32:35]
    buffer_load_dwordx4 v14, s[48:51], s22 offen offset:3072 sc1 lds
    s_add_u32 m0, s77, 12384
    s_sub_u32 s22, s76, 8
    v_mfma_f32_16x16x32_bf16 v[36:39], v[200:203], v[116:119], v[36:39]
    buffer_load_dwordx4 v14, s[48:51], s22 offen sc1 lds
    ds_read_b128 v[80:83], v7 offset:32768
    ds_read_b128 v[84:87], v7 offset:34816
    s_waitcnt lgkmcnt(1)
    v_mfma_f32_16x16x32_bf16 v[32:35], v[204:207], v[80:83], v[32:35]
    buffer_load_dwordx4 v14, s[48:51], s22 offen offset:1024 sc1 lds
    ds_read_b128 v[112:115], v8 offset:32768
    s_waitcnt lgkmcnt(1)
    v_mfma_f32_16x16x32_bf16 v[36:39], v[204:207], v[84:87], v[36:39]
    buffer_load_dwordx4 v14, s[48:51], s22 offen offset:2048 sc1 lds
    buffer_load_dwordx4 v14, s[48:51], s22 offen offset:3072 sc1 lds
    ds_read_b128 v[116:119], v8 offset:34816
    s_waitcnt lgkmcnt(1)
    v_mfma_f32_16x16x32_bf16 v[32:35], v[208:211], v[112:115], v[32:35]
    s_waitcnt lgkmcnt(0)
    v_mfma_f32_16x16x32_bf16 v[36:39], v[208:211], v[116:119], v[36:39]
    s_mov_b32 s92, 0xbfb8aa3b
    s_lshl_b32 s74, s67, 7
    s_lshl_b32 s75, s64, 5
    s_add_u32 s74, s74, s75
    s_lshl_b32 s74, s74, 2
    s_add_u32 s74, s74, 12582912
    v_lshlrev_b32 v212, 2, v1
    v_cvt_pk_bf16_f32 v214, v32, v32
    v_lshlrev_b32 v214, 16, v214
    v_mul_f32 v214, s92, v214
    v_exp_f32 v214, v214
    s_nop 0
    v_add_f32 v214, 1.0, v214
    v_rcp_f32 v214, v214
    s_nop 0
    v_cvt_pk_bf16_f32 v214, v214, v214
    v_lshlrev_b32 v214, 16, v214
    v_cvt_pk_bf16_f32 v215, v36, v36
    v_lshlrev_b32 v215, 16, v215
    v_mul_f32 v215, s92, v215
    v_exp_f32 v215, v215
    s_nop 0
    v_add_f32 v215, 1.0, v215
    v_rcp_f32 v215, v215
    s_nop 0
    v_cvt_pk_bf16_f32 v215, v215, v215
    v_lshlrev_b32 v215, 16, v215
    s_mov_b64 exec, 0xffff
    s_add_u32 s75, s74, 0
    buffer_store_dword v214, v212, s[48:51], s75 offen sc1
    s_add_u32 s75, s74, 64
    buffer_store_dword v215, v212, s[48:51], s75 offen sc1
    s_mov_b64 exec, -1
    s_waitcnt vmcnt(2)
    s_branch G1E_10
CEND:
    s_endpgm
.section .rodata,"a"
.p2align 6
.amdhsa_kernel gated_mix__ssm_conv_s4__dense_activation_relu__prompt_kernel
  .amdhsa_next_free_vgpr 512
  .amdhsa_next_free_sgpr 102
  .amdhsa_accum_offset 256
  .amdhsa_group_segment_fixed_size 0
  .amdhsa_kernarg_size 128
  .amdhsa_user_sgpr_count 2
  .amdhsa_user_sgpr_kernarg_segment_ptr 1
  .amdhsa_system_sgpr_workgroup_id_x 1
.end_amdhsa_kernel
```
